```python
import torch

def _softmax(x, axis=-1):
    return torch.softmax(x, dim=axis)
def _gelu(x):
    return torch.nn.functional.gelu(x, approximate="tanh")
def _silu(x):
    return torch.nn.functional.silu(x)
def _sigmoid(x):
    return torch.sigmoid(x)
def _layernorm(x, axis=-1, eps=1e-5):
    m = x.mean(dim=axis, keepdim=True)
    v = x.var(dim=axis, keepdim=True, unbiased=False)
    return (x - m) / torch.sqrt(v + eps)
def _scatter_add(tgt, idx, src, axis=0):
    return tgt.clone().index_add_(axis, idx, src)
def _segment_sum(src, seg, n):
    out = torch.zeros((n,) + src.shape[1:], dtype=src.dtype)
    return out.index_add_(0, seg, src)
def _pad(x, pw):
    flat = tuple(v for pair in reversed(pw) for v in pair)
    return torch.nn.functional.pad(x, flat)

kernel_name = 'recurrent_scan__gqa_block_cached__swiglu_ffn__decode'

def setup_inputs():

    _w = (lambda a: (lambda t: t.to(torch.bfloat16) if t.is_floating_point() else t)(torch.as_tensor(a)))
    def _A_setup():
        B, Sq, D = 1, 1, 512
        Hq, Hkv, Sk, Dh = 32, 8, 32768, 128
        assert Hq % Hkv == 0, (Hq, Hkv)
        return {
            "x": _w((lambda *s: torch.randn(*s, dtype=torch.bfloat16) * 0.05)(B, Sq, D)),
            "k_cache": _w((lambda *s: torch.randn(*s, dtype=torch.bfloat16) * 0.8)(B, Hkv, Sk, Dh)),
            "v_cache": _w((lambda *s: torch.randn(*s, dtype=torch.bfloat16) * 0.8)(B, Hkv, Sk, Dh)),
            "wq": _w((lambda *s: torch.randn(*s, dtype=torch.bfloat16) * 0.8)(D, Hq * Dh) * (D ** -0.5)),
            "wo": _w((lambda *s: torch.randn(*s, dtype=torch.bfloat16) * 0.8)(Hq * Dh, D) * ((Hq * Dh) ** -0.5)),
        }
    _A_in = _A_setup()

    def _B_setup():
        B, S, D, F = 1, 1, 512, 1792
        return {
            "x": _w((lambda *s: torch.randn(*s, dtype=torch.bfloat16) * 0.05)(B, S, D)),
            "w_gate": _w((lambda *s: torch.randn(*s, dtype=torch.bfloat16) * 0.2)(D, F)),
            "w_up": _w((lambda *s: torch.randn(*s, dtype=torch.bfloat16) * 0.2)(D, F)),
            "w_down": _w((lambda *s: torch.randn(*s, dtype=torch.bfloat16) * 0.2)(F, D)),
        }
    _B_in = _B_setup()

    return {
        "A_x": _A_in["x"],
        "A_k_cache": _A_in["k_cache"],
        "A_v_cache": _A_in["v_cache"],
        "A_wq": _A_in["wq"],
        "A_wo": _A_in["wo"],
        "B_x": _B_in["x"],
        "B_w_gate": _B_in["w_gate"],
        "B_w_up": _B_in["w_up"],
        "B_w_down": _B_in["w_down"],
    }

def reference(A_x, A_k_cache, A_v_cache, A_wq, A_wo, B_x, B_w_gate, B_w_up, B_w_down):
    def _A_ref(x, k_cache, v_cache, wq, wo):
        B, Sq, D = x.shape
        Hq, Dh = 32, 128
        Hkv = k_cache.shape[1]
        rep = Hq // Hkv
        q = (lambda x, *d: x.permute(*d))((x @ wq).reshape(B, Sq, Hq, Dh), 0, 2, 1, 3)
        k = (lambda x, n, axis: torch.repeat_interleave(x, n, dim=axis))(k_cache, rep, axis=1)
        v = (lambda x, n, axis: torch.repeat_interleave(x, n, dim=axis))(v_cache, rep, axis=1)
        scores = torch.einsum("bhqd,bhkd->bhqk", q, k) * (Dh ** -0.5)
        p = _softmax(scores, axis=-1)
        o = torch.einsum("bhqk,bhkd->bhqd", p, v)
        return (lambda x, *d: x.permute(*d))(o, 0, 2, 1, 3).reshape(B, Sq, Hq * Dh) @ wo

    def _B_ref(x, w_gate, w_up, w_down):
        g = _silu(x @ w_gate)
        u = x @ w_up
        return (g * u) @ w_down

    x = A_x
    xn = _layernorm(x, axis=-1)
    s = _A_ref(xn, A_k_cache, A_v_cache, A_wq, A_wo)
    g = _silu(_B_ref(xn, B_w_gate, B_w_up, B_w_down))
    return x + s * g
```

```asm
; @launch grid=(256,1,1) block=(768,1,1) lds=45824
    .amdgcn_target "amdgcn-amd-amdhsa--gfx950"
    .text
    .globl recurrent_scan__gqa_block_cached__swiglu_ffn__decode_kernel
    .p2align 8
    .type recurrent_scan__gqa_block_cached__swiglu_ffn__decode_kernel,@function
recurrent_scan__gqa_block_cached__swiglu_ffn__decode_kernel:
    s_load_dwordx16 s[4:19], s[0:1], 0
    s_cmp_ge_u32 s2, 256
    s_cbranch_scc1 Lend
    v_lshrrev_b32 v1, 6, v0
    v_and_b32 v0, 63, v0
    v_readfirstlane_b32 s3, v1
    s_and_b32 s48, s2, 7
    s_lshr_b32 s49, s2, 3
    s_cmp_lt_u32 s3, 8
    s_cbranch_scc1 Lstream
    v_lshlrev_b32 v3, 4, v0
    s_load_dwordx8 s[20:27], s[0:1], 64
    s_cmp_ge_u32 s49, 1
    s_cbranch_scc1 Lnopf1
    s_getpc_b64 s[44:45]
Lpc:
    s_sub_u32 s44, s44, Lpc-recurrent_scan__gqa_block_cached__swiglu_ffn__decode_kernel
    s_subb_u32 s45, s45, 0
    s_mov_b32 s46, Lcode_end-recurrent_scan__gqa_block_cached__swiglu_ffn__decode_kernel
    s_mov_b32 s47, 0x20000
    s_and_b32 s50, s3, 3
    s_lshl_b32 s50, s50, 10
    buffer_load_dwordx4 v[72:75], v3, s[44:47], s50 offen
    s_add_u32 s50, s50, 4096
    buffer_load_dwordx4 v[76:79], v3, s[44:47], s50 offen
    s_add_u32 s50, s50, 4096
    buffer_load_dwordx4 v[80:83], v3, s[44:47], s50 offen
    s_add_u32 s50, s50, 4096
    buffer_load_dwordx4 v[84:87], v3, s[44:47], s50 offen
    s_add_u32 s50, s50, 4096
    buffer_load_dwordx4 v[88:91], v3, s[44:47], s50 offen
Lnopf1:
    s_barrier
    s_branch Lservice
Lstream:
    s_lshl_b32 s50, s48, 23
    s_lshl_b32 s51, s49, 18
    s_or_b32 s50, s50, s51
    s_lshl_b32 s51, s3, 12
    s_or_b32 s50, s50, s51
    s_lshl_b32 s69, s49, 15
    v_lshlrev_b32 v2, 4, v0
    v_and_b32 v4, 0xc0, v2
    v_lshlrev_b32 v4, 2, v4
    v_lshrrev_b32 v1, 4, v0
    v_lshlrev_b32 v1, 6, v1
    v_and_b32 v5, 48, v2
    v_or3_b32 v1, v1, v4, v5
    v_mov_b32 v3, 0
    s_lshr_b32 s60, s3, 1
    s_cmp_ge_u32 s49, 16
    s_cbranch_scc1 Ls1ffn2
    s_and_b32 s61, s49, 7
    s_lshr_b32 s62, s49, 3
    s_lshl_b32 s63, s62, 2
    s_add_u32 s63, s63, s60
    s_lshl_b32 s63, s63, 6
    s_mov_b32 s64, 8192
    s_lshl_b32 s52, s48, 3
    s_add_u32 s52, s52, s61
    s_mov_b32 s38, 0x400000
    s_mov_b32 s39, 0x20000
    s_branch Ls1join3
Ls1ffn2:
    s_sub_u32 s52, s49, 16
    s_lshl_b32 s53, s48, 4
    s_add_u32 s52, s52, s53
    s_lshr_b32 s61, s52, 2
    s_and_b32 s62, s52, 3
    s_and_b32 s53, s60, 1
    s_lshl_b32 s63, s62, 1
    s_add_u32 s63, s63, s53
    s_lshl_b32 s63, s63, 6
    s_mov_b32 s64, 3584
    s_mov_b32 s52, s61
    s_cmp_lt_u32 s61, 28
    s_cselect_b32 s38, 0x1c0000, 0
    s_mov_b32 s39, 0x20000
Ls1join3:
    s_and_b32 s53, s3, 1
    s_lshl_b32 s53, s53, 2
    s_add_u32 s53, s53, s63
    s_mul_i32 s53, s53, s64
    s_lshl_b32 s65, s52, 7
    s_add_u32 s65, s65, s53
    v_and_b32 v4, 56, v0
    v_mul_u32_u24 v4, s64, v4
    v_and_b32 v5, 0x70, v2
    v_add_u32 v6, v4, v5
    s_mov_b32 s30, 0x4000000
    s_mov_b32 s31, 0x20000
    s_mov_b32 s34, 0x4000000
    s_mov_b32 s35, 0x20000
    s_and_b32 s51, s69, 0x38000
    s_or_b32 s51, s51, s50
    s_mov_b32 s70, 0
    s_mov_b32 s71, 0
    v_mov_b32 v167, 1
    s_waitcnt lgkmcnt(0)
    s_mov_b64 s[28:29], s[6:7]
    buffer_load_dwordx4 v[36:39], v1, s[28:31], s51 offen offset:0 nt
    s_mov_b64 s[32:33], s[8:9]
    s_cmp_ge_u32 s3, 4
    s_cselect_b32 s36, s18, s16
    s_cselect_b32 s37, s19, s17
    s_cmp_ge_u32 s49, 16
    s_cselect_b32 s36, s36, s10
    s_cselect_b32 s37, s37, s11
    buffer_load_dwordx4 v[148:151], v6, s[36:39], s65 offen nt
    s_add_u32 s65, s65, s64
    buffer_load_dwordx4 v[40:43], v1, s[28:31], s51 offen offset:1024 nt
    s_mov_b32 s54, 0xffff0000
    s_mov_b32 s56, 0x05040100
    s_mov_b32 s57, 0x07060302
    s_cmp_lg_u32 s3, 0
    s_cbranch_scc1 Lflags4
    v_lshlrev_b32 v4, 2, v0
    s_mov_b64 exec, 0xffff
    ds_write_b32 v4, v3
    s_mov_b64 exec, -1
    s_waitcnt lgkmcnt(0)
Lflags4:
    s_barrier
    s_mov_b64 exec, 1
    ds_add_u32 v3, v167 offset:32
    s_mov_b64 exec, -1
    ds_read_b64 v[164:165], v3 offset:40
    s_waitcnt vmcnt(2)
    buffer_load_dwordx4 v[152:155], v6, s[36:39], s65 offen nt
    s_add_u32 s65, s65, s64
    s_mov_b64 exec, 1
    ds_add_u32 v3, v167 offset:32
    s_mov_b64 exec, -1
    s_waitcnt vmcnt(2)
    buffer_load_dwordx4 v[44:47], v1, s[28:31], s51 offen offset:2048 nt
    s_mov_b64 exec, 1
    ds_add_u32 v3, v167 offset:32
    s_mov_b64 exec, -1
    ds_read_b64 v[164:165], v3 offset:40
    s_waitcnt vmcnt(2)
    buffer_load_dwordx4 v[156:159], v6, s[36:39], s65 offen nt
    s_add_u32 s65, s65, s64
    s_mov_b64 exec, 1
    ds_add_u32 v3, v167 offset:32
    s_mov_b64 exec, -1
    s_waitcnt vmcnt(2)
    buffer_load_dwordx4 v[48:51], v1, s[28:31], s51 offen offset:3072 nt
    s_mov_b64 exec, 1
    ds_add_u32 v3, v167 offset:32
    s_mov_b64 exec, -1
    ds_read_b64 v[164:165], v3 offset:40
    s_waitcnt vmcnt(2)
    buffer_load_dwordx4 v[160:163], v6, s[36:39], s65 offen nt
    s_mov_b64 exec, 1
    ds_add_u32 v3, v167 offset:32
    s_mov_b64 exec, -1
    s_cmp_gt_u32 s70, 8
    s_cbranch_scc1 Lwin5
    s_waitcnt vmcnt(2)
Lwin5:
    s_add_u32 s51, s69, 32768
    s_and_b32 s51, s51, 0x38000
    s_or_b32 s51, s51, s50
    buffer_load_dwordx4 v[52:55], v1, s[28:31], s51 offen offset:0 nt
    s_mov_b64 exec, 1
    ds_add_u32 v3, v167 offset:32
    s_mov_b64 exec, -1
    ds_read_b64 v[164:165], v3 offset:40
    s_waitcnt vmcnt(3)
    s_waitcnt lgkmcnt(0)
    v_readfirstlane_b32 s70, v164
    v_readfirstlane_b32 s71, v165
    s_cmp_gt_u32 s70, 9
    s_cbranch_scc1 Lwin6
    s_waitcnt vmcnt(2)
Lwin6:
    buffer_load_dwordx4 v[56:59], v1, s[28:31], s51 offen offset:1024 nt
    s_mov_b64 exec, 1
    ds_add_u32 v3, v167 offset:32
    s_mov_b64 exec, -1
    s_waitcnt vmcnt(3)
    s_cmp_gt_u32 s70, 10
    s_cbranch_scc1 Lwin7
    s_waitcnt vmcnt(2)
Lwin7:
    buffer_load_dwordx4 v[60:63], v1, s[28:31], s51 offen offset:2048 nt
    s_mov_b64 exec, 1
    ds_add_u32 v3, v167 offset:32
    s_mov_b64 exec, -1
    ds_read_b64 v[164:165], v3 offset:40
    s_waitcnt vmcnt(3)
    s_waitcnt lgkmcnt(0)
    v_readfirstlane_b32 s70, v164
    v_readfirstlane_b32 s71, v165
    s_cmp_gt_u32 s70, 11
    s_cbranch_scc1 Lwin8
    s_waitcnt vmcnt(2)
Lwin8:
    buffer_load_dwordx4 v[64:67], v1, s[28:31], s51 offen offset:3072 nt
    s_mov_b64 exec, 1
    ds_add_u32 v3, v167 offset:32
    s_mov_b64 exec, -1
    s_lshl_b32 s52, s3, 12
    v_add_u32 v4, s52, v2
    ds_write_b128 v4, v[148:151] offset:2816
    ds_write_b128 v4, v[152:155] offset:3840
    ds_write_b128 v4, v[156:159] offset:4864
    ds_write_b128 v4, v[160:163] offset:5888
    v_mov_b32 v5, 1
    s_mov_b64 exec, 1
    ds_add_u32 v3, v5 offset:24
    s_mov_b64 exec, -1
    s_waitcnt vmcnt(3)
    s_cmp_gt_u32 s70, 12
    s_cbranch_scc1 Lwin9
    s_waitcnt vmcnt(2)
Lwin9:
    s_add_u32 s51, s69, 65536
    s_and_b32 s51, s51, 0x38000
    s_or_b32 s51, s51, s50
    buffer_load_dwordx4 v[68:71], v1, s[28:31], s51 offen offset:0 nt
    s_mov_b64 exec, 1
    ds_add_u32 v3, v167 offset:32
    s_mov_b64 exec, -1
    ds_read_b64 v[164:165], v3 offset:40
    s_waitcnt vmcnt(3)
    s_waitcnt lgkmcnt(0)
    v_readfirstlane_b32 s70, v164
    v_readfirstlane_b32 s71, v165
    s_cmp_gt_u32 s70, 13
    s_cbranch_scc1 Lwin10
    s_waitcnt vmcnt(2)
Lwin10:
    buffer_load_dwordx4 v[72:75], v1, s[28:31], s51 offen offset:1024 nt
    s_mov_b64 exec, 1
    ds_add_u32 v3, v167 offset:32
    s_mov_b64 exec, -1
    s_waitcnt vmcnt(3)
    s_cmp_gt_u32 s70, 14
    s_cbranch_scc1 Lwin11
    s_waitcnt vmcnt(2)
Lwin11:
    buffer_load_dwordx4 v[76:79], v1, s[28:31], s51 offen offset:2048 nt
    s_mov_b64 exec, 1
    ds_add_u32 v3, v167 offset:32
    s_mov_b64 exec, -1
    ds_read_b64 v[164:165], v3 offset:40
    s_waitcnt vmcnt(3)
    s_waitcnt lgkmcnt(0)
    v_readfirstlane_b32 s70, v164
    v_readfirstlane_b32 s71, v165
    s_cmp_gt_u32 s70, 15
    s_cbranch_scc1 Lwin12
    s_waitcnt vmcnt(2)
Lwin12:
    buffer_load_dwordx4 v[80:83], v1, s[28:31], s51 offen offset:3072 nt
    s_mov_b64 exec, 1
    ds_add_u32 v3, v167 offset:32
    s_mov_b64 exec, -1
    s_waitcnt vmcnt(3)
    s_cmp_gt_u32 s70, 16
    s_cbranch_scc1 Lwin13
    s_waitcnt vmcnt(2)
Lwin13:
    s_add_u32 s51, s69, 98304
    s_and_b32 s51, s51, 0x38000
    s_or_b32 s51, s51, s50
    buffer_load_dwordx4 v[84:87], v1, s[28:31], s51 offen offset:0 nt
    s_mov_b64 exec, 1
    ds_add_u32 v3, v167 offset:32
    s_mov_b64 exec, -1
    ds_read_b64 v[164:165], v3 offset:40
    s_waitcnt vmcnt(3)
    s_waitcnt lgkmcnt(0)
    v_readfirstlane_b32 s70, v164
    v_readfirstlane_b32 s71, v165
    s_cmp_gt_u32 s70, 17
    s_cbranch_scc1 Lwin14
    s_waitcnt vmcnt(2)
Lwin14:
    buffer_load_dwordx4 v[88:91], v1, s[28:31], s51 offen offset:1024 nt
    s_mov_b64 exec, 1
    ds_add_u32 v3, v167 offset:32
    s_mov_b64 exec, -1
    s_waitcnt vmcnt(3)
    s_cmp_gt_u32 s70, 18
    s_cbranch_scc1 Lwin15
    s_waitcnt vmcnt(2)
Lwin15:
    buffer_load_dwordx4 v[92:95], v1, s[28:31], s51 offen offset:2048 nt
    s_mov_b64 exec, 1
    ds_add_u32 v3, v167 offset:32
    s_mov_b64 exec, -1
    ds_read_b64 v[164:165], v3 offset:40
    s_waitcnt vmcnt(3)
    s_waitcnt lgkmcnt(0)
    v_readfirstlane_b32 s70, v164
    v_readfirstlane_b32 s71, v165
    s_cmp_gt_u32 s70, 19
    s_cbranch_scc1 Lwin16
    s_waitcnt vmcnt(2)
Lwin16:
    buffer_load_dwordx4 v[96:99], v1, s[28:31], s51 offen offset:3072 nt
    s_mov_b64 exec, 1
    ds_add_u32 v3, v167 offset:32
    s_mov_b64 exec, -1
    s_waitcnt vmcnt(3)
    s_cmp_gt_u32 s70, 20
    s_cbranch_scc1 Lwin17
    s_waitcnt vmcnt(2)
Lwin17:
    s_add_u32 s51, s69, 131072
    s_and_b32 s51, s51, 0x38000
    s_or_b32 s51, s51, s50
    buffer_load_dwordx4 v[100:103], v1, s[28:31], s51 offen offset:0 nt
    s_mov_b64 exec, 1
    ds_add_u32 v3, v167 offset:32
    s_mov_b64 exec, -1
    ds_read_b64 v[164:165], v3 offset:40
    v_mov_b32 v4, 16
    s_mov_b64 exec, 1
    ds_max_u32 v3, v4 offset:16
    s_mov_b64 exec, -1
    s_waitcnt vmcnt(3)
    s_waitcnt lgkmcnt(0)
    v_readfirstlane_b32 s70, v164
    v_readfirstlane_b32 s71, v165
    s_cmp_gt_u32 s70, 21
    s_cbranch_scc1 Lwin18
    s_waitcnt vmcnt(2)
Lwin18:
    buffer_load_dwordx4 v[104:107], v1, s[28:31], s51 offen offset:1024 nt
    s_mov_b64 exec, 1
    ds_add_u32 v3, v167 offset:32
    s_mov_b64 exec, -1
    s_waitcnt vmcnt(3)
    s_cmp_gt_u32 s70, 22
    s_cbranch_scc1 Lwin19
    s_waitcnt vmcnt(2)
Lwin19:
    buffer_load_dwordx4 v[108:111], v1, s[28:31], s51 offen offset:2048 nt
    s_mov_b64 exec, 1
    ds_add_u32 v3, v167 offset:32
    s_mov_b64 exec, -1
    ds_read_b64 v[164:165], v3 offset:40
    s_waitcnt vmcnt(3)
    s_waitcnt lgkmcnt(0)
    v_readfirstlane_b32 s70, v164
    v_readfirstlane_b32 s71, v165
    s_cmp_gt_u32 s70, 23
    s_cbranch_scc1 Lwin20
    s_waitcnt vmcnt(2)
Lwin20:
    buffer_load_dwordx4 v[112:115], v1, s[28:31], s51 offen offset:3072 nt
    s_mov_b64 exec, 1
    ds_add_u32 v3, v167 offset:32
    s_mov_b64 exec, -1
    s_waitcnt vmcnt(3)
    s_cmp_gt_u32 s70, 24
    s_cbranch_scc1 Lwin21
    s_waitcnt vmcnt(2)
Lwin21:
    s_add_u32 s51, s69, 163840
    s_and_b32 s51, s51, 0x38000
    s_or_b32 s51, s51, s50
    buffer_load_dwordx4 v[116:119], v1, s[28:31], s51 offen offset:0 nt
    s_mov_b64 exec, 1
    ds_add_u32 v3, v167 offset:32
    s_mov_b64 exec, -1
    ds_read_b64 v[164:165], v3 offset:40
    s_waitcnt vmcnt(3)
    s_waitcnt lgkmcnt(0)
    v_readfirstlane_b32 s70, v164
    v_readfirstlane_b32 s71, v165
    s_cmp_gt_u32 s70, 25
    s_cbranch_scc1 Lwin22
    s_waitcnt vmcnt(2)
Lwin22:
    buffer_load_dwordx4 v[120:123], v1, s[28:31], s51 offen offset:1024 nt
    s_mov_b64 exec, 1
    ds_add_u32 v3, v167 offset:32
    s_mov_b64 exec, -1
    s_waitcnt vmcnt(3)
    s_cmp_gt_u32 s70, 26
    s_cbranch_scc1 Lwin23
    s_waitcnt vmcnt(2)
Lwin23:
    buffer_load_dwordx4 v[124:127], v1, s[28:31], s51 offen offset:2048 nt
    s_mov_b64 exec, 1
    ds_add_u32 v3, v167 offset:32
    s_mov_b64 exec, -1
    ds_read_b64 v[164:165], v3 offset:40
    s_waitcnt vmcnt(3)
    s_waitcnt lgkmcnt(0)
    v_readfirstlane_b32 s70, v164
    v_readfirstlane_b32 s71, v165
    s_cmp_gt_u32 s70, 27
    s_cbranch_scc1 Lwin24
    s_waitcnt vmcnt(2)
Lwin24:
    buffer_load_dwordx4 v[128:131], v1, s[28:31], s51 offen offset:3072 nt
    s_mov_b64 exec, 1
    ds_add_u32 v3, v167 offset:32
    s_mov_b64 exec, -1
    s_waitcnt vmcnt(3)
    s_cmp_gt_u32 s70, 28
    s_cbranch_scc1 Lwin25
    s_waitcnt vmcnt(2)
Lwin25:
    s_add_u32 s51, s69, 196608
    s_and_b32 s51, s51, 0x38000
    s_or_b32 s51, s51, s50
    buffer_load_dwordx4 v[132:135], v1, s[28:31], s51 offen offset:0 nt
    s_mov_b64 exec, 1
    ds_add_u32 v3, v167 offset:32
    s_mov_b64 exec, -1
    ds_read_b64 v[164:165], v3 offset:40
    s_waitcnt vmcnt(3)
    s_waitcnt lgkmcnt(0)
    v_readfirstlane_b32 s70, v164
    v_readfirstlane_b32 s71, v165
    s_cmp_gt_u32 s70, 29
    s_cbranch_scc1 Lwin26
    s_waitcnt vmcnt(2)
Lwin26:
    buffer_load_dwordx4 v[136:139], v1, s[28:31], s51 offen offset:1024 nt
    s_mov_b64 exec, 1
    ds_add_u32 v3, v167 offset:32
    s_mov_b64 exec, -1
    s_waitcnt vmcnt(3)
    s_cmp_gt_u32 s70, 30
    s_cbranch_scc1 Lwin27
    s_waitcnt vmcnt(2)
Lwin27:
    buffer_load_dwordx4 v[140:143], v1, s[28:31], s51 offen offset:2048 nt
    s_mov_b64 exec, 1
    ds_add_u32 v3, v167 offset:32
    s_mov_b64 exec, -1
    ds_read_b64 v[164:165], v3 offset:40
    s_waitcnt vmcnt(3)
    s_waitcnt lgkmcnt(0)
    v_readfirstlane_b32 s70, v164
    v_readfirstlane_b32 s71, v165
    s_cmp_gt_u32 s70, 31
    s_cbranch_scc1 Lwin28
    s_waitcnt vmcnt(2)
Lwin28:
    buffer_load_dwordx4 v[144:147], v1, s[28:31], s51 offen offset:3072 nt
    s_mov_b64 exec, 1
    ds_add_u32 v3, v167 offset:32
    s_mov_b64 exec, -1
    s_waitcnt vmcnt(3)
    s_cmp_gt_u32 s70, 32
    s_cbranch_scc1 Lwin29
    s_waitcnt vmcnt(2)
Lwin29:
    s_add_u32 s51, s69, 229376
    s_and_b32 s51, s51, 0x38000
    s_or_b32 s51, s51, s50
    buffer_load_dwordx4 v[148:151], v1, s[28:31], s51 offen offset:0 nt
    s_mov_b64 exec, 1
    ds_add_u32 v3, v167 offset:32
    s_mov_b64 exec, -1
    ds_read_b64 v[164:165], v3 offset:40
    v_and_b32 v5, 3, v0
    v_lshlrev_b32 v5, 8, v5
    v_and_b32 v4, 0xc0, v2
    v_lshrrev_b32 v4, 2, v4
    v_and_b32 v20, 0x300, v2
    v_lshrrev_b32 v20, 2, v20
    v_or3_b32 v5, v5, v4, v20
    s_mov_b32 s58, 1048576
Llw30:
    ds_read_b32 v4, v3 offset:0
    ds_read_b128 v[8:11], v5 offset:512
    s_waitcnt lgkmcnt(0)
    v_readfirstlane_b32 s53, v4
    s_nop 0
    s_cmp_ge_u32 s53, 1
    s_cbranch_scc1 Llwx31
    s_sub_u32 s58, s58, 1
    s_cbranch_scc1 Llwx31
    s_sleep 1
    s_branch Llw30
Llwx31:
    v_mfma_f32_16x16x32_bf16 v[20:23], v[36:39], v[8:11], 0
    v_mfma_f32_16x16x32_bf16 v[24:27], v[40:43], v[8:11], 0
    v_mfma_f32_16x16x32_bf16 v[28:31], v[44:47], v[8:11], 0
    v_mfma_f32_16x16x32_bf16 v[32:35], v[48:51], v[8:11], 0
    s_mov_b32 s6, 0xf000f0
    s_mov_b32 s7, 0xf000f0
    s_mov_b32 s8, 0xf000f00
    s_mov_b32 s9, 0xf000f00
    s_mov_b32 s10, 0xf000f000
    s_mov_b32 s11, 0xf000f000
    v_add_f32_dpp v20, v21, v20 row_ror:12 row_mask:0xf bank_mask:0xf
    v_add_f32_dpp v25, v26, v25 row_ror:12 row_mask:0xf bank_mask:0xf
    v_add_f32_dpp v30, v31, v30 row_ror:12 row_mask:0xf bank_mask:0xf
    v_add_f32_dpp v35, v32, v35 row_ror:12 row_mask:0xf bank_mask:0xf
    v_add_f32_dpp v20, v22, v20 row_ror:8 row_mask:0xf bank_mask:0xf
    v_add_f32_dpp v25, v27, v25 row_ror:8 row_mask:0xf bank_mask:0xf
    v_add_f32_dpp v30, v28, v30 row_ror:8 row_mask:0xf bank_mask:0xf
    v_add_f32_dpp v35, v33, v35 row_ror:8 row_mask:0xf bank_mask:0xf
    v_add_f32_dpp v20, v23, v20 row_ror:4 row_mask:0xf bank_mask:0xf
    v_add_f32_dpp v25, v24, v25 row_ror:4 row_mask:0xf bank_mask:0xf
    v_add_f32_dpp v30, v29, v30 row_ror:4 row_mask:0xf bank_mask:0xf
    v_add_f32_dpp v35, v34, v35 row_ror:4 row_mask:0xf bank_mask:0xf
    v_cndmask_b32 v12, v20, v25, s[6:7]
    v_cndmask_b32 v12, v12, v30, s[8:9]
    v_cndmask_b32 v12, v12, v35, s[10:11]
    s_waitcnt vmcnt(3)
    s_waitcnt lgkmcnt(0)
    v_readfirstlane_b32 s70, v164
    v_readfirstlane_b32 s71, v165
    s_cmp_gt_u32 s70, 33
    s_cbranch_scc1 Lwin32
    s_waitcnt vmcnt(2)
Lwin32:
    buffer_load_dwordx4 v[152:155], v1, s[28:31], s51 offen offset:1024 nt
    s_mov_b64 exec, 1
    ds_add_u32 v3, v167 offset:32
    s_mov_b64 exec, -1
    v_mfma_f32_16x16x32_bf16 v[20:23], v[52:55], v[8:11], 0
    v_mfma_f32_16x16x32_bf16 v[24:27], v[56:59], v[8:11], 0
    v_mfma_f32_16x16x32_bf16 v[28:31], v[60:63], v[8:11], 0
    v_mfma_f32_16x16x32_bf16 v[32:35], v[64:67], v[8:11], 0
    s_nop 4
    v_add_f32_dpp v20, v21, v20 row_ror:12 row_mask:0xf bank_mask:0xf
    v_add_f32_dpp v25, v26, v25 row_ror:12 row_mask:0xf bank_mask:0xf
    v_add_f32_dpp v30, v31, v30 row_ror:12 row_mask:0xf bank_mask:0xf
    v_add_f32_dpp v35, v32, v35 row_ror:12 row_mask:0xf bank_mask:0xf
    v_add_f32_dpp v20, v22, v20 row_ror:8 row_mask:0xf bank_mask:0xf
    v_add_f32_dpp v25, v27, v25 row_ror:8 row_mask:0xf bank_mask:0xf
    v_add_f32_dpp v30, v28, v30 row_ror:8 row_mask:0xf bank_mask:0xf
    v_add_f32_dpp v35, v33, v35 row_ror:8 row_mask:0xf bank_mask:0xf
    v_add_f32_dpp v20, v23, v20 row_ror:4 row_mask:0xf bank_mask:0xf
    v_add_f32_dpp v25, v24, v25 row_ror:4 row_mask:0xf bank_mask:0xf
    v_add_f32_dpp v30, v29, v30 row_ror:4 row_mask:0xf bank_mask:0xf
    v_add_f32_dpp v35, v34, v35 row_ror:4 row_mask:0xf bank_mask:0xf
    v_cndmask_b32 v13, v20, v25, s[6:7]
    v_cndmask_b32 v13, v13, v30, s[8:9]
    v_cndmask_b32 v13, v13, v35, s[10:11]
    s_mov_b32 s68, 0x3db504f3
    v_cvt_pk_bf16_f32 v4, v12, v13
    v_lshlrev_b32 v12, 16, v4
    v_and_b32 v13, s54, v4
    v_mul_f32 v12, s68, v12
    v_mul_f32 v13, s68, v13
    v_cvt_pk_bf16_f32 v4, v12, v13
    v_lshlrev_b32 v12, 16, v4
    v_and_b32 v13, s54, v4
    s_waitcnt vmcnt(3)
    s_cmp_gt_u32 s70, 34
    s_cbranch_scc1 Lwin33
    s_waitcnt vmcnt(2)
Lwin33:
    buffer_load_dwordx4 v[156:159], v1, s[28:31], s51 offen offset:2048 nt
    s_mov_b64 exec, 1
    ds_add_u32 v3, v167 offset:32
    s_mov_b64 exec, -1
    ds_read_b64 v[164:165], v3 offset:40
    v_mfma_f32_16x16x32_bf16 v[20:23], v[68:71], v[8:11], 0
    v_mfma_f32_16x16x32_bf16 v[24:27], v[72:75], v[8:11], 0
    v_mfma_f32_16x16x32_bf16 v[28:31], v[76:79], v[8:11], 0
    v_mfma_f32_16x16x32_bf16 v[32:35], v[80:83], v[8:11], 0
    s_nop 4
    v_add_f32_dpp v20, v21, v20 row_ror:12 row_mask:0xf bank_mask:0xf
    v_add_f32_dpp v25, v26, v25 row_ror:12 row_mask:0xf bank_mask:0xf
    v_add_f32_dpp v30, v31, v30 row_ror:12 row_mask:0xf bank_mask:0xf
    v_add_f32_dpp v35, v32, v35 row_ror:12 row_mask:0xf bank_mask:0xf
    v_add_f32_dpp v20, v22, v20 row_ror:8 row_mask:0xf bank_mask:0xf
    v_add_f32_dpp v25, v27, v25 row_ror:8 row_mask:0xf bank_mask:0xf
    v_add_f32_dpp v30, v28, v30 row_ror:8 row_mask:0xf bank_mask:0xf
    v_add_f32_dpp v35, v33, v35 row_ror:8 row_mask:0xf bank_mask:0xf
    v_add_f32_dpp v20, v23, v20 row_ror:4 row_mask:0xf bank_mask:0xf
    v_add_f32_dpp v25, v24, v25 row_ror:4 row_mask:0xf bank_mask:0xf
    v_add_f32_dpp v30, v29, v30 row_ror:4 row_mask:0xf bank_mask:0xf
    v_add_f32_dpp v35, v34, v35 row_ror:4 row_mask:0xf bank_mask:0xf
    v_cndmask_b32 v14, v20, v25, s[6:7]
    v_cndmask_b32 v14, v14, v30, s[8:9]
    v_cndmask_b32 v14, v14, v35, s[10:11]
    s_waitcnt vmcnt(3)
    s_waitcnt lgkmcnt(0)
    v_readfirstlane_b32 s70, v164
    v_readfirstlane_b32 s71, v165
    s_cmp_gt_u32 s70, 35
    s_cbranch_scc1 Lwin34
    s_waitcnt vmcnt(2)
Lwin34:
    buffer_load_dwordx4 v[160:163], v1, s[28:31], s51 offen offset:3072 nt
    s_mov_b64 exec, 1
    ds_add_u32 v3, v167 offset:32
    s_mov_b64 exec, -1
    v_mfma_f32_16x16x32_bf16 v[20:23], v[84:87], v[8:11], 0
    v_mfma_f32_16x16x32_bf16 v[24:27], v[88:91], v[8:11], 0
    v_mfma_f32_16x16x32_bf16 v[28:31], v[92:95], v[8:11], 0
    v_mfma_f32_16x16x32_bf16 v[32:35], v[96:99], v[8:11], 0
    s_nop 4
    v_add_f32_dpp v20, v21, v20 row_ror:12 row_mask:0xf bank_mask:0xf
    v_add_f32_dpp v25, v26, v25 row_ror:12 row_mask:0xf bank_mask:0xf
    v_add_f32_dpp v30, v31, v30 row_ror:12 row_mask:0xf bank_mask:0xf
    v_add_f32_dpp v35, v32, v35 row_ror:12 row_mask:0xf bank_mask:0xf
    v_add_f32_dpp v20, v22, v20 row_ror:8 row_mask:0xf bank_mask:0xf
    v_add_f32_dpp v25, v27, v25 row_ror:8 row_mask:0xf bank_mask:0xf
    v_add_f32_dpp v30, v28, v30 row_ror:8 row_mask:0xf bank_mask:0xf
    v_add_f32_dpp v35, v33, v35 row_ror:8 row_mask:0xf bank_mask:0xf
    v_add_f32_dpp v20, v23, v20 row_ror:4 row_mask:0xf bank_mask:0xf
    v_add_f32_dpp v25, v24, v25 row_ror:4 row_mask:0xf bank_mask:0xf
    v_add_f32_dpp v30, v29, v30 row_ror:4 row_mask:0xf bank_mask:0xf
    v_add_f32_dpp v35, v34, v35 row_ror:4 row_mask:0xf bank_mask:0xf
    v_cndmask_b32 v15, v20, v25, s[6:7]
    v_cndmask_b32 v15, v15, v30, s[8:9]
    v_cndmask_b32 v15, v15, v35, s[10:11]
    v_cvt_pk_bf16_f32 v4, v14, v15
    v_lshlrev_b32 v14, 16, v4
    v_and_b32 v15, s54, v4
    v_mul_f32 v14, s68, v14
    v_mul_f32 v15, s68, v15
    v_cvt_pk_bf16_f32 v4, v14, v15
    v_lshlrev_b32 v14, 16, v4
    v_and_b32 v15, s54, v4
    s_waitcnt vmcnt(3)
    s_cmp_gt_u32 s70, 36
    s_cbranch_scc1 Lwin35
    s_waitcnt vmcnt(2)
Lwin35:
    s_add_u32 s51, s69, 0
    s_and_b32 s51, s51, 0x38000
    s_or_b32 s51, s51, s50
    buffer_load_dwordx4 v[36:39], v2, s[32:35], s51 offen offset:0 nt
    s_mov_b64 exec, 1
    ds_add_u32 v3, v167 offset:32
    s_mov_b64 exec, -1
    ds_read_b64 v[164:165], v3 offset:40
    v_mfma_f32_16x16x32_bf16 v[20:23], v[100:103], v[8:11], 0
    v_mfma_f32_16x16x32_bf16 v[24:27], v[104:107], v[8:11], 0
    v_mfma_f32_16x16x32_bf16 v[28:31], v[108:111], v[8:11], 0
    v_mfma_f32_16x16x32_bf16 v[32:35], v[112:115], v[8:11], 0
    s_nop 4
    v_add_f32_dpp v20, v21, v20 row_ror:12 row_mask:0xf bank_mask:0xf
    v_add_f32_dpp v25, v26, v25 row_ror:12 row_mask:0xf bank_mask:0xf
    v_add_f32_dpp v30, v31, v30 row_ror:12 row_mask:0xf bank_mask:0xf
    v_add_f32_dpp v35, v32, v35 row_ror:12 row_mask:0xf bank_mask:0xf
    v_add_f32_dpp v20, v22, v20 row_ror:8 row_mask:0xf bank_mask:0xf
    v_add_f32_dpp v25, v27, v25 row_ror:8 row_mask:0xf bank_mask:0xf
    v_add_f32_dpp v30, v28, v30 row_ror:8 row_mask:0xf bank_mask:0xf
    v_add_f32_dpp v35, v33, v35 row_ror:8 row_mask:0xf bank_mask:0xf
    v_add_f32_dpp v20, v23, v20 row_ror:4 row_mask:0xf bank_mask:0xf
    v_add_f32_dpp v25, v24, v25 row_ror:4 row_mask:0xf bank_mask:0xf
    v_add_f32_dpp v30, v29, v30 row_ror:4 row_mask:0xf bank_mask:0xf
    v_add_f32_dpp v35, v34, v35 row_ror:4 row_mask:0xf bank_mask:0xf
    v_cndmask_b32 v16, v20, v25, s[6:7]
    v_cndmask_b32 v16, v16, v30, s[8:9]
    v_cndmask_b32 v16, v16, v35, s[10:11]
    s_waitcnt vmcnt(3)
    s_waitcnt lgkmcnt(0)
    v_readfirstlane_b32 s70, v164
    v_readfirstlane_b32 s71, v165
    s_cmp_gt_u32 s70, 37
    s_cbranch_scc1 Lwin36
    s_waitcnt vmcnt(2)
Lwin36:
    buffer_load_dwordx4 v[40:43], v2, s[32:35], s51 offen offset:1024 nt
    s_mov_b64 exec, 1
    ds_add_u32 v3, v167 offset:32
    s_mov_b64 exec, -1
    v_mfma_f32_16x16x32_bf16 v[20:23], v[116:119], v[8:11], 0
    v_mfma_f32_16x16x32_bf16 v[24:27], v[120:123], v[8:11], 0
    v_mfma_f32_16x16x32_bf16 v[28:31], v[124:127], v[8:11], 0
    v_mfma_f32_16x16x32_bf16 v[32:35], v[128:131], v[8:11], 0
    s_nop 4
    v_add_f32_dpp v20, v21, v20 row_ror:12 row_mask:0xf bank_mask:0xf
    v_add_f32_dpp v25, v26, v25 row_ror:12 row_mask:0xf bank_mask:0xf
    v_add_f32_dpp v30, v31, v30 row_ror:12 row_mask:0xf bank_mask:0xf
    v_add_f32_dpp v35, v32, v35 row_ror:12 row_mask:0xf bank_mask:0xf
    v_add_f32_dpp v20, v22, v20 row_ror:8 row_mask:0xf bank_mask:0xf
    v_add_f32_dpp v25, v27, v25 row_ror:8 row_mask:0xf bank_mask:0xf
    v_add_f32_dpp v30, v28, v30 row_ror:8 row_mask:0xf bank_mask:0xf
    v_add_f32_dpp v35, v33, v35 row_ror:8 row_mask:0xf bank_mask:0xf
    v_add_f32_dpp v20, v23, v20 row_ror:4 row_mask:0xf bank_mask:0xf
    v_add_f32_dpp v25, v24, v25 row_ror:4 row_mask:0xf bank_mask:0xf
    v_add_f32_dpp v30, v29, v30 row_ror:4 row_mask:0xf bank_mask:0xf
    v_add_f32_dpp v35, v34, v35 row_ror:4 row_mask:0xf bank_mask:0xf
    v_cndmask_b32 v17, v20, v25, s[6:7]
    v_cndmask_b32 v17, v17, v30, s[8:9]
    v_cndmask_b32 v17, v17, v35, s[10:11]
    v_cvt_pk_bf16_f32 v4, v16, v17
    v_lshlrev_b32 v16, 16, v4
    v_and_b32 v17, s54, v4
    v_mul_f32 v16, s68, v16
    v_mul_f32 v17, s68, v17
    v_cvt_pk_bf16_f32 v4, v16, v17
    v_lshlrev_b32 v16, 16, v4
    v_and_b32 v17, s54, v4
    s_waitcnt vmcnt(3)
    s_cmp_gt_u32 s70, 38
    s_cbranch_scc1 Lwin37
    s_waitcnt vmcnt(2)
Lwin37:
    buffer_load_dwordx4 v[44:47], v2, s[32:35], s51 offen offset:2048 nt
    s_mov_b64 exec, 1
    ds_add_u32 v3, v167 offset:32
    s_mov_b64 exec, -1
    ds_read_b64 v[164:165], v3 offset:40
    v_mfma_f32_16x16x32_bf16 v[20:23], v[132:135], v[8:11], 0
    v_mfma_f32_16x16x32_bf16 v[24:27], v[136:139], v[8:11], 0
    v_mfma_f32_16x16x32_bf16 v[28:31], v[140:143], v[8:11], 0
    v_mfma_f32_16x16x32_bf16 v[32:35], v[144:147], v[8:11], 0
    s_nop 4
    v_add_f32_dpp v20, v21, v20 row_ror:12 row_mask:0xf bank_mask:0xf
    v_add_f32_dpp v25, v26, v25 row_ror:12 row_mask:0xf bank_mask:0xf
    v_add_f32_dpp v30, v31, v30 row_ror:12 row_mask:0xf bank_mask:0xf
    v_add_f32_dpp v35, v32, v35 row_ror:12 row_mask:0xf bank_mask:0xf
    v_add_f32_dpp v20, v22, v20 row_ror:8 row_mask:0xf bank_mask:0xf
    v_add_f32_dpp v25, v27, v25 row_ror:8 row_mask:0xf bank_mask:0xf
    v_add_f32_dpp v30, v28, v30 row_ror:8 row_mask:0xf bank_mask:0xf
    v_add_f32_dpp v35, v33, v35 row_ror:8 row_mask:0xf bank_mask:0xf
    v_add_f32_dpp v20, v23, v20 row_ror:4 row_mask:0xf bank_mask:0xf
    v_add_f32_dpp v25, v24, v25 row_ror:4 row_mask:0xf bank_mask:0xf
    v_add_f32_dpp v30, v29, v30 row_ror:4 row_mask:0xf bank_mask:0xf
    v_add_f32_dpp v35, v34, v35 row_ror:4 row_mask:0xf bank_mask:0xf
    v_cndmask_b32 v18, v20, v25, s[6:7]
    v_cndmask_b32 v18, v18, v30, s[8:9]
    v_cndmask_b32 v18, v18, v35, s[10:11]
    s_waitcnt vmcnt(3)
    s_waitcnt lgkmcnt(0)
    v_readfirstlane_b32 s70, v164
    v_readfirstlane_b32 s71, v165
    s_cmp_gt_u32 s70, 39
    s_cbranch_scc1 Lwin38
    s_waitcnt vmcnt(2)
Lwin38:
    buffer_load_dwordx4 v[48:51], v2, s[32:35], s51 offen offset:3072 nt
    s_mov_b64 exec, 1
    ds_add_u32 v3, v167 offset:32
    s_mov_b64 exec, -1
    v_mfma_f32_16x16x32_bf16 v[20:23], v[148:151], v[8:11], 0
    v_mfma_f32_16x16x32_bf16 v[24:27], v[152:155], v[8:11], 0
    v_mfma_f32_16x16x32_bf16 v[28:31], v[156:159], v[8:11], 0
    v_mfma_f32_16x16x32_bf16 v[32:35], v[160:163], v[8:11], 0
    s_nop 4
    v_add_f32_dpp v20, v21, v20 row_ror:12 row_mask:0xf bank_mask:0xf
    v_add_f32_dpp v25, v26, v25 row_ror:12 row_mask:0xf bank_mask:0xf
    v_add_f32_dpp v30, v31, v30 row_ror:12 row_mask:0xf bank_mask:0xf
    v_add_f32_dpp v35, v32, v35 row_ror:12 row_mask:0xf bank_mask:0xf
    v_add_f32_dpp v20, v22, v20 row_ror:8 row_mask:0xf bank_mask:0xf
    v_add_f32_dpp v25, v27, v25 row_ror:8 row_mask:0xf bank_mask:0xf
    v_add_f32_dpp v30, v28, v30 row_ror:8 row_mask:0xf bank_mask:0xf
    v_add_f32_dpp v35, v33, v35 row_ror:8 row_mask:0xf bank_mask:0xf
    v_add_f32_dpp v20, v23, v20 row_ror:4 row_mask:0xf bank_mask:0xf
    v_add_f32_dpp v25, v24, v25 row_ror:4 row_mask:0xf bank_mask:0xf
    v_add_f32_dpp v30, v29, v30 row_ror:4 row_mask:0xf bank_mask:0xf
    v_add_f32_dpp v35, v34, v35 row_ror:4 row_mask:0xf bank_mask:0xf
    v_cndmask_b32 v19, v20, v25, s[6:7]
    v_cndmask_b32 v19, v19, v30, s[8:9]
    v_cndmask_b32 v19, v19, v35, s[10:11]
    v_cvt_pk_bf16_f32 v4, v18, v19
    v_lshlrev_b32 v18, 16, v4
    v_and_b32 v19, s54, v4
    v_mul_f32 v18, s68, v18
    v_mul_f32 v19, s68, v19
    v_cvt_pk_bf16_f32 v4, v18, v19
    v_lshlrev_b32 v18, 16, v4
    v_and_b32 v19, s54, v4
    s_waitcnt vmcnt(3)
    s_cmp_gt_u32 s70, 40
    s_cbranch_scc1 Lwin39
    s_waitcnt vmcnt(2)
Lwin39:
    s_add_u32 s51, s69, 32768
    s_and_b32 s51, s51, 0x38000
    s_or_b32 s51, s51, s50
    buffer_load_dwordx4 v[52:55], v2, s[32:35], s51 offen offset:0 nt
    s_mov_b64 exec, 1
    ds_add_u32 v3, v167 offset:32
    s_mov_b64 exec, -1
    ds_read_b64 v[164:165], v3 offset:40
    v_max3_f32 v20, v12, v13, v14
    v_max3_f32 v20, v20, v15, v16
    v_max3_f32 v20, v20, v17, v18
    v_max_f32 v20, v20, v19
    s_nop 1
    v_max_f32_dpp v20, v20, v20 row_ror:4 row_mask:0xf bank_mask:0xf
    s_nop 1
    v_max_f32_dpp v20, v20, v20 row_ror:8 row_mask:0xf bank_mask:0xf
    v_mov_b32 v4, v20
    s_nop 1
    v_permlane16_swap_b32 v20, v4
    v_max_f32 v20, v20, v4
    v_mov_b32 v4, v20
    s_nop 1
    v_permlane32_swap_b32 v20, v4
    v_max_f32 v20, v20, v4
    s_waitcnt vmcnt(3)
    s_waitcnt lgkmcnt(0)
    v_readfirstlane_b32 s70, v164
    v_readfirstlane_b32 s71, v165
    s_cmp_gt_u32 s70, 41
    s_cbranch_scc1 Lwin40
    s_waitcnt vmcnt(2)
Lwin40:
    buffer_load_dwordx4 v[56:59], v2, s[32:35], s51 offen offset:1024 nt
    s_mov_b64 exec, 1
    ds_add_u32 v3, v167 offset:32
    s_mov_b64 exec, -1
    s_mov_b32 s52, 0x3fb8aa3b
    v_sub_f32 v12, v12, v20
    v_sub_f32 v13, v13, v20
    v_sub_f32 v14, v14, v20
    v_sub_f32 v15, v15, v20
    v_sub_f32 v16, v16, v20
    v_sub_f32 v17, v17, v20
    v_sub_f32 v18, v18, v20
    v_sub_f32 v19, v19, v20
    v_mul_f32 v12, s52, v12
    v_mul_f32 v13, s52, v13
    v_mul_f32 v14, s52, v14
    v_mul_f32 v15, s52, v15
    v_mul_f32 v16, s52, v16
    v_mul_f32 v17, s52, v17
    v_mul_f32 v18, s52, v18
    v_mul_f32 v19, s52, v19
    v_exp_f32 v12, v12
    v_exp_f32 v13, v13
    v_exp_f32 v14, v14
    v_exp_f32 v15, v15
    v_exp_f32 v16, v16
    v_exp_f32 v17, v17
    v_exp_f32 v18, v18
    v_exp_f32 v19, v19
    s_waitcnt vmcnt(3)
    s_cmp_gt_u32 s70, 42
    s_cbranch_scc1 Lwin41
    s_waitcnt vmcnt(2)
Lwin41:
    buffer_load_dwordx4 v[60:63], v2, s[32:35], s51 offen offset:2048 nt
    s_mov_b64 exec, 1
    ds_add_u32 v3, v167 offset:32
    s_mov_b64 exec, -1
    ds_read_b64 v[164:165], v3 offset:40
    v_add_f32 v21, v12, v13
    v_add_f32 v21, v21, v14
    v_add_f32 v21, v21, v15
    v_add_f32 v21, v21, v16
    v_add_f32 v21, v21, v17
    v_add_f32 v21, v21, v18
    v_add_f32 v21, v21, v19
    s_nop 1
    v_add_f32_dpp v21, v21, v21 row_ror:4 row_mask:0xf bank_mask:0xf
    s_nop 1
    v_add_f32_dpp v21, v21, v21 row_ror:8 row_mask:0xf bank_mask:0xf
    v_mov_b32 v4, v21
    s_nop 1
    v_permlane16_swap_b32 v21, v4
    v_add_f32 v21, v21, v4
    v_mov_b32 v4, v21
    s_nop 1
    v_permlane32_swap_b32 v21, v4
    v_add_f32 v21, v21, v4
    s_lshl_b32 s52, s3, 5
    v_lshl_add_u32 v4, v0, 2, s52
    v_mov_b32 v5, 1
    s_mov_b64 exec, 15
    ds_write2_b32 v4, v20, v21 offset0:16 offset1:20
    s_mov_b64 exec, 1
    ds_add_u32 v3, v5 offset:4
    s_mov_b64 exec, -1
    s_waitcnt vmcnt(3)
    s_waitcnt lgkmcnt(0)
    v_readfirstlane_b32 s70, v164
    v_readfirstlane_b32 s71, v165
    s_cmp_gt_u32 s70, 43
    s_cbranch_scc1 Lwin42
    s_waitcnt vmcnt(2)
Lwin42:
    buffer_load_dwordx4 v[64:67], v2, s[32:35], s51 offen offset:3072 nt
    s_mov_b64 exec, 1
    ds_add_u32 v3, v167 offset:32
    s_mov_b64 exec, -1
    s_mul_i32 s52, s3, 2304
    v_and_b32 v4, 15, v0
    v_mul_u32_u24 v4, 144, v4
    v_and_b32 v7, 48, v0
    v_add3_u32 v7, v7, v4, s52
    v_mov_b32 v100, 0
    v_mov_b32 v101, 0
    v_mov_b32 v102, 0
    v_mov_b32 v103, 0
    v_mov_b32 v104, 0
    v_mov_b32 v105, 0
    v_mov_b32 v106, 0
    v_mov_b32 v107, 0
    v_mov_b32 v108, 0
    v_mov_b32 v109, 0
    v_mov_b32 v110, 0
    v_mov_b32 v111, 0
    v_mov_b32 v112, 0
    v_mov_b32 v113, 0
    v_mov_b32 v114, 0
    v_mov_b32 v115, 0
    v_mov_b32 v116, 0
    v_mov_b32 v117, 0
    v_mov_b32 v118, 0
    v_mov_b32 v119, 0
    v_mov_b32 v120, 0
    v_mov_b32 v121, 0
    v_mov_b32 v122, 0
    v_mov_b32 v123, 0
    v_mov_b32 v20, 0
    v_mov_b32 v21, 0
    v_mov_b32 v22, 0
    v_mov_b32 v23, 0
    v_mov_b32 v24, 0
    v_mov_b32 v25, 0
    v_mov_b32 v26, 0
    v_mov_b32 v27, 0
    v_mov_b32 v28, 0
    v_mov_b32 v29, 0
    v_mov_b32 v30, 0
    v_mov_b32 v31, 0
    v_mov_b32 v32, 0
    v_mov_b32 v33, 0
    v_mov_b32 v34, 0
    v_mov_b32 v35, 0
    s_waitcnt vmcnt(3)
    s_cmp_gt_u32 s70, 44
    s_cbranch_scc1 Lwin43
    s_waitcnt vmcnt(2)
Lwin43:
    s_add_u32 s51, s69, 65536
    s_and_b32 s51, s51, 0x38000
    s_or_b32 s51, s51, s50
    buffer_load_dwordx4 v[68:71], v2, s[32:35], s51 offen offset:0 nt
    s_mov_b64 exec, 1
    ds_add_u32 v3, v167 offset:32
    s_mov_b64 exec, -1
    ds_read_b64 v[164:165], v3 offset:40
    v_cvt_pk_bf16_f32 v4, v12, v13
    s_nop 1
    v_mov_b32_dpp v108, v4 quad_perm:[0,1,2,3] row_mask:0xf bank_mask:0x1
    v_mov_b32_dpp v112, v4 row_ror:4 row_mask:0xf bank_mask:0x2
    v_mov_b32_dpp v116, v4 row_ror:8 row_mask:0xf bank_mask:0x4
    v_mov_b32_dpp v120, v4 row_ror:12 row_mask:0xf bank_mask:0x8
    v_mov_b32_dpp v109, v4 row_ror:12 row_mask:0xf bank_mask:0x1
    v_mov_b32_dpp v113, v4 quad_perm:[0,1,2,3] row_mask:0xf bank_mask:0x2
    v_mov_b32_dpp v117, v4 row_ror:4 row_mask:0xf bank_mask:0x4
    v_mov_b32_dpp v121, v4 row_ror:8 row_mask:0xf bank_mask:0x8
    v_mov_b32_dpp v110, v4 row_ror:8 row_mask:0xf bank_mask:0x1
    v_mov_b32_dpp v114, v4 row_ror:12 row_mask:0xf bank_mask:0x2
    v_mov_b32_dpp v118, v4 quad_perm:[0,1,2,3] row_mask:0xf bank_mask:0x4
    v_mov_b32_dpp v122, v4 row_ror:4 row_mask:0xf bank_mask:0x8
    v_mov_b32_dpp v111, v4 row_ror:4 row_mask:0xf bank_mask:0x1
    v_mov_b32_dpp v115, v4 row_ror:8 row_mask:0xf bank_mask:0x2
    v_mov_b32_dpp v119, v4 row_ror:12 row_mask:0xf bank_mask:0x4
    v_mov_b32_dpp v123, v4 quad_perm:[0,1,2,3] row_mask:0xf bank_mask:0x8
    s_waitcnt vmcnt(3)
    s_waitcnt lgkmcnt(0)
    v_readfirstlane_b32 s70, v164
    v_readfirstlane_b32 s71, v165
    s_cmp_gt_u32 s70, 45
    s_cbranch_scc1 Lwin44
    s_waitcnt vmcnt(2)
Lwin44:
    buffer_load_dwordx4 v[72:75], v2, s[32:35], s51 offen offset:1024 nt
    s_mov_b64 exec, 1
    ds_add_u32 v3, v167 offset:32
    s_mov_b64 exec, -1
    v_cvt_pk_bf16_f32 v4, v12, v13
    v_lshlrev_b32 v8, 16, v4
    v_and_b32 v9, s54, v4
    v_sub_f32 v8, v12, v8
    v_sub_f32 v9, v13, v9
    v_cvt_pk_bf16_f32 v4, v8, v9
    s_nop 1
    v_mov_b32_dpp v20, v4 quad_perm:[0,1,2,3] row_mask:0xf bank_mask:0x1
    v_mov_b32_dpp v24, v4 row_ror:4 row_mask:0xf bank_mask:0x2
    v_mov_b32_dpp v28, v4 row_ror:8 row_mask:0xf bank_mask:0x4
    v_mov_b32_dpp v32, v4 row_ror:12 row_mask:0xf bank_mask:0x8
    v_mov_b32_dpp v21, v4 row_ror:12 row_mask:0xf bank_mask:0x1
    v_mov_b32_dpp v25, v4 quad_perm:[0,1,2,3] row_mask:0xf bank_mask:0x2
    v_mov_b32_dpp v29, v4 row_ror:4 row_mask:0xf bank_mask:0x4
    v_mov_b32_dpp v33, v4 row_ror:8 row_mask:0xf bank_mask:0x8
    v_mov_b32_dpp v22, v4 row_ror:8 row_mask:0xf bank_mask:0x1
    v_mov_b32_dpp v26, v4 row_ror:12 row_mask:0xf bank_mask:0x2
    v_mov_b32_dpp v30, v4 quad_perm:[0,1,2,3] row_mask:0xf bank_mask:0x4
    v_mov_b32_dpp v34, v4 row_ror:4 row_mask:0xf bank_mask:0x8
    v_mov_b32_dpp v23, v4 row_ror:4 row_mask:0xf bank_mask:0x1
    v_mov_b32_dpp v27, v4 row_ror:8 row_mask:0xf bank_mask:0x2
    v_mov_b32_dpp v31, v4 row_ror:12 row_mask:0xf bank_mask:0x4
    v_mov_b32_dpp v35, v4 quad_perm:[0,1,2,3] row_mask:0xf bank_mask:0x8
    s_waitcnt vmcnt(3)
    s_cmp_gt_u32 s70, 46
    s_cbranch_scc1 Lwin45
    s_waitcnt vmcnt(2)
Lwin45:
    buffer_load_dwordx4 v[76:79], v2, s[32:35], s51 offen offset:2048 nt
    s_mov_b64 exec, 1
    ds_add_u32 v3, v167 offset:32
    s_mov_b64 exec, -1
    ds_read_b64 v[164:165], v3 offset:40
    v_perm_b32 v128, v52, v36, s56
    v_perm_b32 v132, v52, v36, s57
    v_perm_b32 v136, v53, v37, s56
    v_perm_b32 v140, v53, v37, s57
    v_perm_b32 v144, v54, v38, s56
    v_perm_b32 v148, v54, v38, s57
    v_perm_b32 v152, v55, v39, s56
    v_perm_b32 v156, v55, v39, s57
    s_waitcnt vmcnt(3)
    s_waitcnt lgkmcnt(0)
    v_readfirstlane_b32 s70, v164
    v_readfirstlane_b32 s71, v165
    s_cmp_gt_u32 s70, 47
    s_cbranch_scc1 Lwin46
    s_waitcnt vmcnt(2)
Lwin46:
    buffer_load_dwordx4 v[80:83], v2, s[32:35], s51 offen offset:3072 nt
    s_mov_b64 exec, 1
    ds_add_u32 v3, v167 offset:32
    s_mov_b64 exec, -1
    v_perm_b32 v129, v56, v40, s56
    v_perm_b32 v133, v56, v40, s57
    v_perm_b32 v137, v57, v41, s56
    v_perm_b32 v141, v57, v41, s57
    v_perm_b32 v145, v58, v42, s56
    v_perm_b32 v149, v58, v42, s57
    v_perm_b32 v153, v59, v43, s56
    v_perm_b32 v157, v59, v43, s57
    s_waitcnt vmcnt(3)
    s_cmp_gt_u32 s70, 48
    s_cbranch_scc1 Lwin47
    s_waitcnt vmcnt(2)
Lwin47:
    s_add_u32 s51, s69, 98304
    s_and_b32 s51, s51, 0x38000
    s_or_b32 s51, s51, s50
    buffer_load_dwordx4 v[84:87], v2, s[32:35], s51 offen offset:0 nt
    s_mov_b64 exec, 1
    ds_add_u32 v3, v167 offset:32
    s_mov_b64 exec, -1
    ds_read_b64 v[164:165], v3 offset:40
    v_mov_b32 v4, 44
    s_mov_b64 exec, 1
    ds_max_u32 v3, v4 offset:16
    s_mov_b64 exec, -1
    v_perm_b32 v130, v60, v44, s56
    v_perm_b32 v134, v60, v44, s57
    v_perm_b32 v138, v61, v45, s56
    v_perm_b32 v142, v61, v45, s57
    v_perm_b32 v146, v62, v46, s56
    v_perm_b32 v150, v62, v46, s57
    v_perm_b32 v154, v63, v47, s56
    v_perm_b32 v158, v63, v47, s57
    s_waitcnt vmcnt(3)
    s_waitcnt lgkmcnt(0)
    v_readfirstlane_b32 s70, v164
    v_readfirstlane_b32 s71, v165
    s_cmp_gt_u32 s70, 49
    s_cbranch_scc1 Lwin48
    s_waitcnt vmcnt(2)
Lwin48:
    buffer_load_dwordx4 v[88:91], v2, s[32:35], s51 offen offset:1024 nt
    s_mov_b64 exec, 1
    ds_add_u32 v3, v167 offset:32
    s_mov_b64 exec, -1
    v_perm_b32 v131, v64, v48, s56
    v_perm_b32 v147, v66, v50, s56
    v_perm_b32 v135, v64, v48, s57
    v_mfma_f32_16x16x32_bf16 v[100:103], v[108:111], v[128:131], v[100:103]
    v_mfma_f32_16x16x32_bf16 v[100:103], v[20:23], v[128:131], v[100:103]
    v_perm_b32 v151, v66, v50, s57
    v_mfma_f32_16x16x32_bf16 v[104:107], v[108:111], v[144:147], v[104:107]
    v_mfma_f32_16x16x32_bf16 v[104:107], v[20:23], v[144:147], v[104:107]
    v_perm_b32 v139, v65, v49, s56
    v_mfma_f32_16x16x32_bf16 v[100:103], v[112:115], v[132:135], v[100:103]
    v_mfma_f32_16x16x32_bf16 v[100:103], v[24:27], v[132:135], v[100:103]
    v_perm_b32 v155, v67, v51, s56
    v_mfma_f32_16x16x32_bf16 v[104:107], v[112:115], v[148:151], v[104:107]
    v_mfma_f32_16x16x32_bf16 v[104:107], v[24:27], v[148:151], v[104:107]
    v_perm_b32 v143, v65, v49, s57
    v_mfma_f32_16x16x32_bf16 v[100:103], v[116:119], v[136:139], v[100:103]
    v_mfma_f32_16x16x32_bf16 v[100:103], v[28:31], v[136:139], v[100:103]
    v_perm_b32 v159, v67, v51, s57
    v_mfma_f32_16x16x32_bf16 v[104:107], v[116:119], v[152:155], v[104:107]
    v_mfma_f32_16x16x32_bf16 v[104:107], v[28:31], v[152:155], v[104:107]
    v_mfma_f32_16x16x32_bf16 v[100:103], v[120:123], v[140:143], v[100:103]
    v_mfma_f32_16x16x32_bf16 v[100:103], v[32:35], v[140:143], v[100:103]
    v_mfma_f32_16x16x32_bf16 v[104:107], v[120:123], v[156:159], v[104:107]
    v_mfma_f32_16x16x32_bf16 v[104:107], v[32:35], v[156:159], v[104:107]
    s_waitcnt vmcnt(3)
    s_cmp_gt_u32 s70, 50
    s_cbranch_scc1 Lwin49
    s_waitcnt vmcnt(2)
Lwin49:
    buffer_load_dwordx4 v[92:95], v2, s[32:35], s51 offen offset:2048 nt
    s_mov_b64 exec, 1
    ds_add_u32 v3, v167 offset:32
    s_mov_b64 exec, -1
    ds_read_b64 v[164:165], v3 offset:40
    v_cvt_pk_bf16_f32 v4, v14, v15
    s_nop 1
    v_mov_b32_dpp v108, v4 quad_perm:[0,1,2,3] row_mask:0xf bank_mask:0x1
    v_mov_b32_dpp v112, v4 row_ror:4 row_mask:0xf bank_mask:0x2
    v_mov_b32_dpp v116, v4 row_ror:8 row_mask:0xf bank_mask:0x4
    v_mov_b32_dpp v120, v4 row_ror:12 row_mask:0xf bank_mask:0x8
    v_mov_b32_dpp v109, v4 row_ror:12 row_mask:0xf bank_mask:0x1
    v_mov_b32_dpp v113, v4 quad_perm:[0,1,2,3] row_mask:0xf bank_mask:0x2
    v_mov_b32_dpp v117, v4 row_ror:4 row_mask:0xf bank_mask:0x4
    v_mov_b32_dpp v121, v4 row_ror:8 row_mask:0xf bank_mask:0x8
    v_mov_b32_dpp v110, v4 row_ror:8 row_mask:0xf bank_mask:0x1
    v_mov_b32_dpp v114, v4 row_ror:12 row_mask:0xf bank_mask:0x2
    v_mov_b32_dpp v118, v4 quad_perm:[0,1,2,3] row_mask:0xf bank_mask:0x4
    v_mov_b32_dpp v122, v4 row_ror:4 row_mask:0xf bank_mask:0x8
    v_mov_b32_dpp v111, v4 row_ror:4 row_mask:0xf bank_mask:0x1
    v_mov_b32_dpp v115, v4 row_ror:8 row_mask:0xf bank_mask:0x2
    v_mov_b32_dpp v119, v4 row_ror:12 row_mask:0xf bank_mask:0x4
    v_mov_b32_dpp v123, v4 quad_perm:[0,1,2,3] row_mask:0xf bank_mask:0x8
    s_waitcnt vmcnt(3)
    s_waitcnt lgkmcnt(0)
    v_readfirstlane_b32 s70, v164
    v_readfirstlane_b32 s71, v165
    s_cmp_gt_u32 s70, 51
    s_cbranch_scc1 Lwin50
    s_waitcnt vmcnt(2)
Lwin50:
    buffer_load_dwordx4 v[96:99], v2, s[32:35], s51 offen offset:3072 nt
    s_mov_b64 exec, 1
    ds_add_u32 v3, v167 offset:32
    s_mov_b64 exec, -1
    v_cvt_pk_bf16_f32 v4, v14, v15
    v_lshlrev_b32 v8, 16, v4
    v_and_b32 v9, s54, v4
    v_sub_f32 v8, v14, v8
    v_sub_f32 v9, v15, v9
    v_cvt_pk_bf16_f32 v4, v8, v9
    s_nop 1
    v_mov_b32_dpp v20, v4 quad_perm:[0,1,2,3] row_mask:0xf bank_mask:0x1
    v_mov_b32_dpp v24, v4 row_ror:4 row_mask:0xf bank_mask:0x2
    v_mov_b32_dpp v28, v4 row_ror:8 row_mask:0xf bank_mask:0x4
    v_mov_b32_dpp v32, v4 row_ror:12 row_mask:0xf bank_mask:0x8
    v_mov_b32_dpp v21, v4 row_ror:12 row_mask:0xf bank_mask:0x1
    v_mov_b32_dpp v25, v4 quad_perm:[0,1,2,3] row_mask:0xf bank_mask:0x2
    v_mov_b32_dpp v29, v4 row_ror:4 row_mask:0xf bank_mask:0x4
    v_mov_b32_dpp v33, v4 row_ror:8 row_mask:0xf bank_mask:0x8
    v_mov_b32_dpp v22, v4 row_ror:8 row_mask:0xf bank_mask:0x1
    v_mov_b32_dpp v26, v4 row_ror:12 row_mask:0xf bank_mask:0x2
    v_mov_b32_dpp v30, v4 quad_perm:[0,1,2,3] row_mask:0xf bank_mask:0x4
    v_mov_b32_dpp v34, v4 row_ror:4 row_mask:0xf bank_mask:0x8
    v_mov_b32_dpp v23, v4 row_ror:4 row_mask:0xf bank_mask:0x1
    v_mov_b32_dpp v27, v4 row_ror:8 row_mask:0xf bank_mask:0x2
    v_mov_b32_dpp v31, v4 row_ror:12 row_mask:0xf bank_mask:0x4
    v_mov_b32_dpp v35, v4 quad_perm:[0,1,2,3] row_mask:0xf bank_mask:0x8
    s_waitcnt vmcnt(3)
    s_cmp_gt_u32 s70, 52
    s_cbranch_scc1 Lwin51
    s_waitcnt vmcnt(2)
Lwin51:
    s_add_u32 s51, s69, 131072
    s_and_b32 s51, s51, 0x38000
    s_or_b32 s51, s51, s50
    buffer_load_dwordx4 v[36:39], v2, s[32:35], s51 offen offset:0 nt
    s_mov_b64 exec, 1
    ds_add_u32 v3, v167 offset:32
    s_mov_b64 exec, -1
    ds_read_b64 v[164:165], v3 offset:40
    v_perm_b32 v128, v84, v68, s56
    v_perm_b32 v132, v84, v68, s57
    v_perm_b32 v136, v85, v69, s56
    v_perm_b32 v140, v85, v69, s57
    v_perm_b32 v144, v86, v70, s56
    v_perm_b32 v148, v86, v70, s57
    v_perm_b32 v152, v87, v71, s56
    v_perm_b32 v156, v87, v71, s57
    s_waitcnt vmcnt(3)
    s_waitcnt lgkmcnt(0)
    v_readfirstlane_b32 s70, v164
    v_readfirstlane_b32 s71, v165
    s_cmp_gt_u32 s70, 53
    s_cbranch_scc1 Lwin52
    s_waitcnt vmcnt(2)
Lwin52:
    buffer_load_dwordx4 v[40:43], v2, s[32:35], s51 offen offset:1024 nt
    s_mov_b64 exec, 1
    ds_add_u32 v3, v167 offset:32
    s_mov_b64 exec, -1
    v_perm_b32 v129, v88, v72, s56
    v_perm_b32 v133, v88, v72, s57
    v_perm_b32 v137, v89, v73, s56
    v_perm_b32 v141, v89, v73, s57
    v_perm_b32 v145, v90, v74, s56
    v_perm_b32 v149, v90, v74, s57
    v_perm_b32 v153, v91, v75, s56
    v_perm_b32 v157, v91, v75, s57
    s_waitcnt vmcnt(3)
    s_cmp_gt_u32 s70, 54
    s_cbranch_scc1 Lwin53
    s_waitcnt vmcnt(2)
Lwin53:
    buffer_load_dwordx4 v[44:47], v2, s[32:35], s51 offen offset:2048 nt
    s_mov_b64 exec, 1
    ds_add_u32 v3, v167 offset:32
    s_mov_b64 exec, -1
    ds_read_b64 v[164:165], v3 offset:40
    v_perm_b32 v130, v92, v76, s56
    v_perm_b32 v134, v92, v76, s57
    v_perm_b32 v138, v93, v77, s56
    v_perm_b32 v142, v93, v77, s57
    v_perm_b32 v146, v94, v78, s56
    v_perm_b32 v150, v94, v78, s57
    v_perm_b32 v154, v95, v79, s56
    v_perm_b32 v158, v95, v79, s57
    s_waitcnt vmcnt(3)
    s_waitcnt lgkmcnt(0)
    v_readfirstlane_b32 s70, v164
    v_readfirstlane_b32 s71, v165
    s_cmp_gt_u32 s70, 55
    s_cbranch_scc1 Lwin54
    s_waitcnt vmcnt(2)
Lwin54:
    buffer_load_dwordx4 v[48:51], v2, s[32:35], s51 offen offset:3072 nt
    s_mov_b64 exec, 1
    ds_add_u32 v3, v167 offset:32
    s_mov_b64 exec, -1
    v_perm_b32 v131, v96, v80, s56
    v_perm_b32 v147, v98, v82, s56
    v_perm_b32 v135, v96, v80, s57
    v_mfma_f32_16x16x32_bf16 v[100:103], v[108:111], v[128:131], v[100:103]
    v_mfma_f32_16x16x32_bf16 v[100:103], v[20:23], v[128:131], v[100:103]
    v_perm_b32 v151, v98, v82, s57
    v_mfma_f32_16x16x32_bf16 v[104:107], v[108:111], v[144:147], v[104:107]
    v_mfma_f32_16x16x32_bf16 v[104:107], v[20:23], v[144:147], v[104:107]
    v_perm_b32 v139, v97, v81, s56
    v_mfma_f32_16x16x32_bf16 v[100:103], v[112:115], v[132:135], v[100:103]
    v_mfma_f32_16x16x32_bf16 v[100:103], v[24:27], v[132:135], v[100:103]
    v_perm_b32 v155, v99, v83, s56
    v_mfma_f32_16x16x32_bf16 v[104:107], v[112:115], v[148:151], v[104:107]
    v_mfma_f32_16x16x32_bf16 v[104:107], v[24:27], v[148:151], v[104:107]
    v_perm_b32 v143, v97, v81, s57
    v_mfma_f32_16x16x32_bf16 v[100:103], v[116:119], v[136:139], v[100:103]
    v_mfma_f32_16x16x32_bf16 v[100:103], v[28:31], v[136:139], v[100:103]
    v_perm_b32 v159, v99, v83, s57
    v_mfma_f32_16x16x32_bf16 v[104:107], v[116:119], v[152:155], v[104:107]
    v_mfma_f32_16x16x32_bf16 v[104:107], v[28:31], v[152:155], v[104:107]
    v_mfma_f32_16x16x32_bf16 v[100:103], v[120:123], v[140:143], v[100:103]
    v_mfma_f32_16x16x32_bf16 v[100:103], v[32:35], v[140:143], v[100:103]
    v_mfma_f32_16x16x32_bf16 v[104:107], v[120:123], v[156:159], v[104:107]
    v_mfma_f32_16x16x32_bf16 v[104:107], v[32:35], v[156:159], v[104:107]
    s_waitcnt vmcnt(3)
    s_cmp_gt_u32 s70, 56
    s_cbranch_scc1 Lwin55
    s_waitcnt vmcnt(2)
Lwin55:
    s_add_u32 s51, s69, 163840
    s_and_b32 s51, s51, 0x38000
    s_or_b32 s51, s51, s50
    buffer_load_dwordx4 v[52:55], v2, s[32:35], s51 offen offset:0 nt
    s_mov_b64 exec, 1
    ds_add_u32 v3, v167 offset:32
    s_mov_b64 exec, -1
    ds_read_b64 v[164:165], v3 offset:40
    v_cvt_pk_bf16_f32 v4, v16, v17
    s_nop 1
    v_mov_b32_dpp v108, v4 quad_perm:[0,1,2,3] row_mask:0xf bank_mask:0x1
    v_mov_b32_dpp v112, v4 row_ror:4 row_mask:0xf bank_mask:0x2
    v_mov_b32_dpp v116, v4 row_ror:8 row_mask:0xf bank_mask:0x4
    v_mov_b32_dpp v120, v4 row_ror:12 row_mask:0xf bank_mask:0x8
    v_mov_b32_dpp v109, v4 row_ror:12 row_mask:0xf bank_mask:0x1
    v_mov_b32_dpp v113, v4 quad_perm:[0,1,2,3] row_mask:0xf bank_mask:0x2
    v_mov_b32_dpp v117, v4 row_ror:4 row_mask:0xf bank_mask:0x4
    v_mov_b32_dpp v121, v4 row_ror:8 row_mask:0xf bank_mask:0x8
    v_mov_b32_dpp v110, v4 row_ror:8 row_mask:0xf bank_mask:0x1
    v_mov_b32_dpp v114, v4 row_ror:12 row_mask:0xf bank_mask:0x2
    v_mov_b32_dpp v118, v4 quad_perm:[0,1,2,3] row_mask:0xf bank_mask:0x4
    v_mov_b32_dpp v122, v4 row_ror:4 row_mask:0xf bank_mask:0x8
    v_mov_b32_dpp v111, v4 row_ror:4 row_mask:0xf bank_mask:0x1
    v_mov_b32_dpp v115, v4 row_ror:8 row_mask:0xf bank_mask:0x2
    v_mov_b32_dpp v119, v4 row_ror:12 row_mask:0xf bank_mask:0x4
    v_mov_b32_dpp v123, v4 quad_perm:[0,1,2,3] row_mask:0xf bank_mask:0x8
    s_waitcnt vmcnt(3)
    s_waitcnt lgkmcnt(0)
    v_readfirstlane_b32 s70, v164
    v_readfirstlane_b32 s71, v165
    s_cmp_gt_u32 s70, 57
    s_cbranch_scc1 Lwin56
    s_waitcnt vmcnt(2)
Lwin56:
    buffer_load_dwordx4 v[56:59], v2, s[32:35], s51 offen offset:1024 nt
    s_mov_b64 exec, 1
    ds_add_u32 v3, v167 offset:32
    s_mov_b64 exec, -1
    v_cvt_pk_bf16_f32 v4, v16, v17
    v_lshlrev_b32 v8, 16, v4
    v_and_b32 v9, s54, v4
    v_sub_f32 v8, v16, v8
    v_sub_f32 v9, v17, v9
    v_cvt_pk_bf16_f32 v4, v8, v9
    s_nop 1
    v_mov_b32_dpp v20, v4 quad_perm:[0,1,2,3] row_mask:0xf bank_mask:0x1
    v_mov_b32_dpp v24, v4 row_ror:4 row_mask:0xf bank_mask:0x2
    v_mov_b32_dpp v28, v4 row_ror:8 row_mask:0xf bank_mask:0x4
    v_mov_b32_dpp v32, v4 row_ror:12 row_mask:0xf bank_mask:0x8
    v_mov_b32_dpp v21, v4 row_ror:12 row_mask:0xf bank_mask:0x1
    v_mov_b32_dpp v25, v4 quad_perm:[0,1,2,3] row_mask:0xf bank_mask:0x2
    v_mov_b32_dpp v29, v4 row_ror:4 row_mask:0xf bank_mask:0x4
    v_mov_b32_dpp v33, v4 row_ror:8 row_mask:0xf bank_mask:0x8
    v_mov_b32_dpp v22, v4 row_ror:8 row_mask:0xf bank_mask:0x1
    v_mov_b32_dpp v26, v4 row_ror:12 row_mask:0xf bank_mask:0x2
    v_mov_b32_dpp v30, v4 quad_perm:[0,1,2,3] row_mask:0xf bank_mask:0x4
    v_mov_b32_dpp v34, v4 row_ror:4 row_mask:0xf bank_mask:0x8
    v_mov_b32_dpp v23, v4 row_ror:4 row_mask:0xf bank_mask:0x1
    v_mov_b32_dpp v27, v4 row_ror:8 row_mask:0xf bank_mask:0x2
    v_mov_b32_dpp v31, v4 row_ror:12 row_mask:0xf bank_mask:0x4
    v_mov_b32_dpp v35, v4 quad_perm:[0,1,2,3] row_mask:0xf bank_mask:0x8
    s_waitcnt vmcnt(3)
    s_cmp_gt_u32 s70, 58
    s_cbranch_scc1 Lwin57
    s_waitcnt vmcnt(2)
Lwin57:
    buffer_load_dwordx4 v[60:63], v2, s[32:35], s51 offen offset:2048 nt
    s_mov_b64 exec, 1
    ds_add_u32 v3, v167 offset:32
    s_mov_b64 exec, -1
    ds_read_b64 v[164:165], v3 offset:40
    s_waitcnt vmcnt(3)
    s_waitcnt lgkmcnt(0)
    v_readfirstlane_b32 s70, v164
    v_readfirstlane_b32 s71, v165
    s_cmp_gt_u32 s70, 59
    s_cbranch_scc1 Lwin58
    s_waitcnt vmcnt(2)
Lwin58:
    buffer_load_dwordx4 v[64:67], v2, s[32:35], s51 offen offset:3072 nt
    s_mov_b64 exec, 1
    ds_add_u32 v3, v167 offset:32
    s_mov_b64 exec, -1
    s_waitcnt vmcnt(3)
    s_cmp_gt_u32 s70, 60
    s_cbranch_scc1 Lwin59
    s_waitcnt vmcnt(2)
Lwin59:
    s_add_u32 s51, s69, 196608
    s_and_b32 s51, s51, 0x38000
    s_or_b32 s51, s51, s50
    buffer_load_dwordx4 v[68:71], v2, s[32:35], s51 offen offset:0 nt
    s_mov_b64 exec, 1
    ds_add_u32 v3, v167 offset:32
    s_mov_b64 exec, -1
    ds_read_b64 v[164:165], v3 offset:40
    v_mov_b32 v4, 56
    s_mov_b64 exec, 1
    ds_max_u32 v3, v4 offset:16
    s_mov_b64 exec, -1
    v_perm_b32 v128, v52, v36, s56
    v_perm_b32 v132, v52, v36, s57
    v_perm_b32 v136, v53, v37, s56
    v_perm_b32 v140, v53, v37, s57
    v_perm_b32 v144, v54, v38, s56
    v_perm_b32 v148, v54, v38, s57
    v_perm_b32 v152, v55, v39, s56
    v_perm_b32 v156, v55, v39, s57
    s_waitcnt vmcnt(3)
    s_waitcnt lgkmcnt(0)
    v_readfirstlane_b32 s70, v164
    v_readfirstlane_b32 s71, v165
    s_cmp_gt_u32 s70, 61
    s_cbranch_scc1 Lwin60
    s_waitcnt vmcnt(2)
Lwin60:
    buffer_load_dwordx4 v[72:75], v2, s[32:35], s51 offen offset:1024 nt
    s_mov_b64 exec, 1
    ds_add_u32 v3, v167 offset:32
    s_mov_b64 exec, -1
    v_perm_b32 v129, v56, v40, s56
    v_perm_b32 v133, v56, v40, s57
    v_perm_b32 v137, v57, v41, s56
    v_perm_b32 v141, v57, v41, s57
    v_perm_b32 v145, v58, v42, s56
    v_perm_b32 v149, v58, v42, s57
    v_perm_b32 v153, v59, v43, s56
    v_perm_b32 v157, v59, v43, s57
    s_waitcnt vmcnt(3)
    s_cmp_gt_u32 s70, 62
    s_cbranch_scc1 Lwin61
    s_waitcnt vmcnt(2)
Lwin61:
    buffer_load_dwordx4 v[76:79], v2, s[32:35], s51 offen offset:2048 nt
    s_mov_b64 exec, 1
    ds_add_u32 v3, v167 offset:32
    s_mov_b64 exec, -1
    ds_read_b64 v[164:165], v3 offset:40
    v_perm_b32 v130, v60, v44, s56
    v_perm_b32 v134, v60, v44, s57
    v_perm_b32 v138, v61, v45, s56
    v_perm_b32 v142, v61, v45, s57
    v_perm_b32 v146, v62, v46, s56
    v_perm_b32 v150, v62, v46, s57
    v_perm_b32 v154, v63, v47, s56
    v_perm_b32 v158, v63, v47, s57
    s_waitcnt vmcnt(3)
    s_waitcnt lgkmcnt(0)
    v_readfirstlane_b32 s70, v164
    v_readfirstlane_b32 s71, v165
    s_cmp_gt_u32 s70, 63
    s_cbranch_scc1 Lwin62
    s_waitcnt vmcnt(2)
Lwin62:
    buffer_load_dwordx4 v[80:83], v2, s[32:35], s51 offen offset:3072 nt
    s_mov_b64 exec, 1
    ds_add_u32 v3, v167 offset:32
    s_mov_b64 exec, -1
    v_perm_b32 v131, v64, v48, s56
    v_perm_b32 v147, v66, v50, s56
    v_perm_b32 v135, v64, v48, s57
    v_mfma_f32_16x16x32_bf16 v[100:103], v[108:111], v[128:131], v[100:103]
    v_mfma_f32_16x16x32_bf16 v[100:103], v[20:23], v[128:131], v[100:103]
    v_perm_b32 v151, v66, v50, s57
    v_mfma_f32_16x16x32_bf16 v[104:107], v[108:111], v[144:147], v[104:107]
    v_mfma_f32_16x16x32_bf16 v[104:107], v[20:23], v[144:147], v[104:107]
    v_perm_b32 v139, v65, v49, s56
    v_mfma_f32_16x16x32_bf16 v[100:103], v[112:115], v[132:135], v[100:103]
    v_mfma_f32_16x16x32_bf16 v[100:103], v[24:27], v[132:135], v[100:103]
    v_perm_b32 v155, v67, v51, s56
    v_mfma_f32_16x16x32_bf16 v[104:107], v[112:115], v[148:151], v[104:107]
    v_mfma_f32_16x16x32_bf16 v[104:107], v[24:27], v[148:151], v[104:107]
    v_perm_b32 v143, v65, v49, s57
    v_mfma_f32_16x16x32_bf16 v[100:103], v[116:119], v[136:139], v[100:103]
    v_mfma_f32_16x16x32_bf16 v[100:103], v[28:31], v[136:139], v[100:103]
    v_perm_b32 v159, v67, v51, s57
    v_mfma_f32_16x16x32_bf16 v[104:107], v[116:119], v[152:155], v[104:107]
    v_mfma_f32_16x16x32_bf16 v[104:107], v[28:31], v[152:155], v[104:107]
    v_mfma_f32_16x16x32_bf16 v[100:103], v[120:123], v[140:143], v[100:103]
    v_mfma_f32_16x16x32_bf16 v[100:103], v[32:35], v[140:143], v[100:103]
    v_mfma_f32_16x16x32_bf16 v[104:107], v[120:123], v[156:159], v[104:107]
    v_mfma_f32_16x16x32_bf16 v[104:107], v[32:35], v[156:159], v[104:107]
    s_waitcnt vmcnt(3)
    s_cmp_gt_u32 s70, 64
    s_cbranch_scc1 Lwin63
    s_waitcnt vmcnt(2)
Lwin63:
    s_add_u32 s51, s69, 229376
    s_and_b32 s51, s51, 0x38000
    s_or_b32 s51, s51, s50
    buffer_load_dwordx4 v[84:87], v2, s[32:35], s51 offen offset:0 nt
    s_mov_b64 exec, 1
    ds_add_u32 v3, v167 offset:32
    s_mov_b64 exec, -1
    ds_read_b64 v[164:165], v3 offset:40
    v_cvt_pk_bf16_f32 v4, v18, v19
    s_nop 1
    v_mov_b32_dpp v108, v4 quad_perm:[0,1,2,3] row_mask:0xf bank_mask:0x1
    v_mov_b32_dpp v112, v4 row_ror:4 row_mask:0xf bank_mask:0x2
    v_mov_b32_dpp v116, v4 row_ror:8 row_mask:0xf bank_mask:0x4
    v_mov_b32_dpp v120, v4 row_ror:12 row_mask:0xf bank_mask:0x8
    v_mov_b32_dpp v109, v4 row_ror:12 row_mask:0xf bank_mask:0x1
    v_mov_b32_dpp v113, v4 quad_perm:[0,1,2,3] row_mask:0xf bank_mask:0x2
    v_mov_b32_dpp v117, v4 row_ror:4 row_mask:0xf bank_mask:0x4
    v_mov_b32_dpp v121, v4 row_ror:8 row_mask:0xf bank_mask:0x8
    v_mov_b32_dpp v110, v4 row_ror:8 row_mask:0xf bank_mask:0x1
    v_mov_b32_dpp v114, v4 row_ror:12 row_mask:0xf bank_mask:0x2
    v_mov_b32_dpp v118, v4 quad_perm:[0,1,2,3] row_mask:0xf bank_mask:0x4
    v_mov_b32_dpp v122, v4 row_ror:4 row_mask:0xf bank_mask:0x8
    v_mov_b32_dpp v111, v4 row_ror:4 row_mask:0xf bank_mask:0x1
    v_mov_b32_dpp v115, v4 row_ror:8 row_mask:0xf bank_mask:0x2
    v_mov_b32_dpp v119, v4 row_ror:12 row_mask:0xf bank_mask:0x4
    v_mov_b32_dpp v123, v4 quad_perm:[0,1,2,3] row_mask:0xf bank_mask:0x8
    s_waitcnt vmcnt(3)
    s_waitcnt lgkmcnt(0)
    v_readfirstlane_b32 s70, v164
    v_readfirstlane_b32 s71, v165
    s_cmp_gt_u32 s70, 65
    s_cbranch_scc1 Lwin64
    s_waitcnt vmcnt(2)
Lwin64:
    buffer_load_dwordx4 v[88:91], v2, s[32:35], s51 offen offset:1024 nt
    s_mov_b64 exec, 1
    ds_add_u32 v3, v167 offset:32
    s_mov_b64 exec, -1
    s_waitcnt vmcnt(3)
    s_cmp_gt_u32 s70, 66
    s_cbranch_scc1 Lwin65
    s_waitcnt vmcnt(2)
Lwin65:
    buffer_load_dwordx4 v[92:95], v2, s[32:35], s51 offen offset:2048 nt
    s_mov_b64 exec, 1
    ds_add_u32 v3, v167 offset:32
    s_mov_b64 exec, -1
    ds_read_b64 v[164:165], v3 offset:40
    s_waitcnt vmcnt(3)
    s_waitcnt lgkmcnt(0)
    v_readfirstlane_b32 s70, v164
    v_readfirstlane_b32 s71, v165
    s_cmp_gt_u32 s70, 67
    s_cbranch_scc1 Lwin66
    s_waitcnt vmcnt(2)
Lwin66:
    buffer_load_dwordx4 v[96:99], v2, s[32:35], s51 offen offset:3072 nt
    s_mov_b64 exec, 1
    ds_add_u32 v3, v167 offset:32
    s_mov_b64 exec, -1
    v_mov_b32 v5, 1
    s_mov_b64 exec, 1
    ds_add_u32 v3, v5 offset:28
    s_mov_b64 exec, -1
    s_waitcnt vmcnt(3)
    v_perm_b32 v128, v84, v68, s56
    v_perm_b32 v132, v84, v68, s57
    v_perm_b32 v136, v85, v69, s56
    v_perm_b32 v140, v85, v69, s57
    v_perm_b32 v144, v86, v70, s56
    v_perm_b32 v148, v86, v70, s57
    v_perm_b32 v152, v87, v71, s56
    v_perm_b32 v156, v87, v71, s57
    s_waitcnt vmcnt(2)
    v_perm_b32 v129, v88, v72, s56
    v_perm_b32 v133, v88, v72, s57
    v_perm_b32 v137, v89, v73, s56
    v_perm_b32 v141, v89, v73, s57
    v_perm_b32 v145, v90, v74, s56
    v_perm_b32 v149, v90, v74, s57
    v_perm_b32 v153, v91, v75, s56
    v_perm_b32 v157, v91, v75, s57
    s_waitcnt vmcnt(1)
    v_perm_b32 v130, v92, v76, s56
    v_perm_b32 v134, v92, v76, s57
    v_perm_b32 v138, v93, v77, s56
    v_perm_b32 v142, v93, v77, s57
    v_perm_b32 v146, v94, v78, s56
    v_perm_b32 v150, v94, v78, s57
    v_perm_b32 v154, v95, v79, s56
    v_perm_b32 v158, v95, v79, s57
    s_waitcnt vmcnt(0)
    v_perm_b32 v131, v96, v80, s56
    v_perm_b32 v135, v96, v80, s57
    v_perm_b32 v139, v97, v81, s56
    v_mfma_f32_16x16x32_bf16 v[100:103], v[108:111], v[128:131], v[100:103]
    v_perm_b32 v143, v97, v81, s57
    v_mfma_f32_16x16x32_bf16 v[100:103], v[112:115], v[132:135], v[100:103]
    v_perm_b32 v147, v98, v82, s56
    v_mfma_f32_16x16x32_bf16 v[100:103], v[116:119], v[136:139], v[100:103]
    v_perm_b32 v151, v98, v82, s57
    v_mfma_f32_16x16x32_bf16 v[100:103], v[120:123], v[140:143], v[100:103]
    v_perm_b32 v155, v99, v83, s56
    v_mfma_f32_16x16x32_bf16 v[104:107], v[108:111], v[144:147], v[104:107]
    v_perm_b32 v159, v99, v83, s57
    v_mfma_f32_16x16x32_bf16 v[104:107], v[112:115], v[148:151], v[104:107]
    v_mfma_f32_16x16x32_bf16 v[104:107], v[116:119], v[152:155], v[104:107]
    v_mfma_f32_16x16x32_bf16 v[104:107], v[120:123], v[156:159], v[104:107]
    s_nop 1
    ds_write_b128 v7, v[100:103] offset:2816
    s_nop 4
    ds_write_b128 v7, v[104:107] offset:2880
    s_waitcnt lgkmcnt(0)
    s_barrier
    s_endpgm
Lservice:
    s_setprio 3
    s_mov_b32 s54, 0xffff0000
    s_mov_b32 s55, 0x3f
    s_and_b32 s60, s3, 3
    v_mov_b32 v1, 0
    v_lshlrev_b32 v3, 4, v0
    s_cmp_ge_u32 s49, 16
    s_cbranch_scc1 Ls1ffn67
    s_and_b32 s61, s49, 7
    s_lshr_b32 s62, s49, 3
    s_lshl_b32 s63, s62, 2
    s_add_u32 s63, s63, s60
    s_lshl_b32 s63, s63, 6
    s_branch Ls1join68
Ls1ffn67:
    s_sub_u32 s52, s49, 16
    s_lshl_b32 s53, s48, 4
    s_add_u32 s52, s52, s53
    s_lshr_b32 s61, s52, 2
    s_and_b32 s62, s52, 3
    s_and_b32 s53, s60, 1
    s_lshl_b32 s63, s62, 1
    s_add_u32 s63, s63, s53
    s_lshl_b32 s63, s63, 6
Ls1join68:
    s_waitcnt lgkmcnt(0)
    s_mov_b32 s28, s26
    s_mov_b32 s29, s27
    s_mov_b32 s30, 0xe0000
    s_mov_b32 s31, 0x20000
    s_mov_b32 s32, s4
    s_mov_b32 s33, s5
    s_mov_b32 s34, 0x400
    s_mov_b32 s35, 0x20000
    buffer_load_dwordx4 v[12:15], v3, s[32:35], 0 offen
    buffer_load_dword v2, v1, s[28:31], 0 offen offset:0
    s_waitcnt vmcnt(1)
    v_lshlrev_b32 v16, 16, v12
    v_and_b32 v17, s54, v12
    v_lshlrev_b32 v18, 16, v13
    v_and_b32 v19, s54, v13
    v_lshlrev_b32 v20, 16, v14
    v_and_b32 v21, s54, v14
    v_lshlrev_b32 v22, 16, v15
    v_and_b32 v23, s54, v15
    v_add_f32 v4, v16, v17
    v_add_f32 v4, v4, v18
    v_add_f32 v4, v4, v19
    v_add_f32 v4, v4, v20
    v_add_f32 v4, v4, v21
    v_add_f32 v4, v4, v22
    v_add_f32 v4, v4, v23
    s_nop 1
    v_add_f32_dpp v4, v4, v4 row_ror:8 row_mask:0xf bank_mask:0xf
    s_nop 1
    v_add_f32_dpp v4, v4, v4 row_ror:4 row_mask:0xf bank_mask:0xf
    s_nop 1
    v_add_f32_dpp v4, v4, v4 row_ror:2 row_mask:0xf bank_mask:0xf
    s_nop 1
    v_add_f32_dpp v4, v4, v4 row_ror:1 row_mask:0xf bank_mask:0xf
    v_mov_b32 v5, v4
    s_nop 1
    v_permlane16_swap_b32 v4, v5
    v_add_f32 v4, v4, v5
    v_mov_b32 v5, v4
    s_nop 1
    v_permlane32_swap_b32 v4, v5
    v_add_f32 v4, v4, v5
    v_mul_f32 v4, 0x3b000000, v4
    v_sub_f32 v6, v16, v4
    v_mul_f32 v7, v6, v6
    v_sub_f32 v6, v17, v4
    v_fmac_f32 v7, v6, v6
    v_sub_f32 v6, v18, v4
    v_fmac_f32 v7, v6, v6
    v_sub_f32 v6, v19, v4
    v_fmac_f32 v7, v6, v6
    v_sub_f32 v6, v20, v4
    v_fmac_f32 v7, v6, v6
    v_sub_f32 v6, v21, v4
    v_fmac_f32 v7, v6, v6
    v_sub_f32 v6, v22, v4
    v_fmac_f32 v7, v6, v6
    v_sub_f32 v6, v23, v4
    v_fmac_f32 v7, v6, v6
    s_nop 1
    v_add_f32_dpp v7, v7, v7 row_ror:8 row_mask:0xf bank_mask:0xf
    s_nop 1
    v_add_f32_dpp v7, v7, v7 row_ror:4 row_mask:0xf bank_mask:0xf
    s_nop 1
    v_add_f32_dpp v7, v7, v7 row_ror:2 row_mask:0xf bank_mask:0xf
    s_nop 1
    v_add_f32_dpp v7, v7, v7 row_ror:1 row_mask:0xf bank_mask:0xf
    v_mov_b32 v5, v7
    s_nop 1
    v_permlane16_swap_b32 v7, v5
    v_add_f32 v7, v7, v5
    v_mov_b32 v5, v7
    s_nop 1
    v_permlane32_swap_b32 v7, v5
    v_add_f32 v7, v7, v5
    v_mul_f32 v7, 0x3b000000, v7
    v_cvt_pk_bf16_f32 v5, v4, v7
    v_lshlrev_b32 v4, 16, v5
    v_and_b32 v7, s54, v5
    v_add_f32 v7, 0x3727c5ac, v7
    v_cvt_pk_bf16_f32 v7, v7, v7
    v_and_b32 v7, s54, v7
    v_sqrt_f32 v7, v7
    s_nop 0
    v_cvt_pk_bf16_f32 v7, v7, v7
    v_and_b32 v7, s54, v7
    v_rcp_f32 v6, v7
    v_sub_f32 v16, v16, v4
    v_sub_f32 v17, v17, v4
    v_sub_f32 v18, v18, v4
    v_sub_f32 v19, v19, v4
    v_sub_f32 v20, v20, v4
    v_sub_f32 v21, v21, v4
    v_sub_f32 v22, v22, v4
    v_sub_f32 v23, v23, v4
    v_cvt_pk_bf16_f32 v5, v16, v17
    v_lshlrev_b32 v16, 16, v5
    v_and_b32 v17, s54, v5
    v_cvt_pk_bf16_f32 v5, v18, v19
    v_lshlrev_b32 v18, 16, v5
    v_and_b32 v19, s54, v5
    v_cvt_pk_bf16_f32 v5, v20, v21
    v_lshlrev_b32 v20, 16, v5
    v_and_b32 v21, s54, v5
    v_cvt_pk_bf16_f32 v5, v22, v23
    v_lshlrev_b32 v22, 16, v5
    v_and_b32 v23, s54, v5
    v_mul_f32 v8, v16, v6
    v_fma_f32 v9, -v8, v7, v16
    v_fma_f32 v16, v9, v6, v8
    v_mul_f32 v8, v17, v6
    v_fma_f32 v9, -v8, v7, v17
    v_fma_f32 v17, v9, v6, v8
    v_mul_f32 v8, v18, v6
    v_fma_f32 v9, -v8, v7, v18
    v_fma_f32 v18, v9, v6, v8
    v_mul_f32 v8, v19, v6
    v_fma_f32 v9, -v8, v7, v19
    v_fma_f32 v19, v9, v6, v8
    v_mul_f32 v8, v20, v6
    v_fma_f32 v9, -v8, v7, v20
    v_fma_f32 v20, v9, v6, v8
    v_mul_f32 v8, v21, v6
    v_fma_f32 v9, -v8, v7, v21
    v_fma_f32 v21, v9, v6, v8
    v_mul_f32 v8, v22, v6
    v_fma_f32 v9, -v8, v7, v22
    v_fma_f32 v22, v9, v6, v8
    v_mul_f32 v8, v23, v6
    v_fma_f32 v9, -v8, v7, v23
    v_fma_f32 v23, v9, v6, v8
    v_cvt_pk_bf16_f32 v5, v16, v17
    v_lshlrev_b32 v16, 16, v5
    v_and_b32 v17, s54, v5
    v_cvt_pk_bf16_f32 v5, v18, v19
    v_lshlrev_b32 v18, 16, v5
    v_and_b32 v19, s54, v5
    v_cvt_pk_bf16_f32 v5, v20, v21
    v_lshlrev_b32 v20, 16, v5
    v_and_b32 v21, s54, v5
    v_cvt_pk_bf16_f32 v5, v22, v23
    v_lshlrev_b32 v22, 16, v5
    v_and_b32 v23, s54, v5
    s_lshr_b32 s50, s63, 1
    v_lshrrev_b32 v4, 3, v0
    v_lshl_add_u32 v4, v4, 2, s50
    ds_bpermute_b32 v24, v4, v16
    ds_bpermute_b32 v25, v4, v17
    ds_bpermute_b32 v26, v4, v18
    ds_bpermute_b32 v27, v4, v19
    ds_bpermute_b32 v28, v4, v20
    ds_bpermute_b32 v29, v4, v21
    ds_bpermute_b32 v30, v4, v22
    ds_bpermute_b32 v31, v4, v23
    s_waitcnt vmcnt(0)
    v_add_u32 v2, 1, v2
    s_nop 0
    v_readfirstlane_b32 s59, v2
    v_and_b32 v2, s55, v2
    s_cmp_lg_u32 s60, 0
    s_cbranch_scc1 Lhello69
    s_getreg_b32 s65, hwreg(HW_REG_XCC_ID, 0, 4)
    s_lshl_b32 s50, s59, 4
    s_or_b32 s65, s65, s50
    s_lshl_b32 s67, s48, 7
    s_add_u32 s67, s67, 0xc000
    s_lshl_b32 s50, s49, 2
    s_add_u32 s50, s50, s67
    v_mov_b32 v6, s65
    s_mov_b64 exec, 1
    buffer_store_dword v6, v1, s[28:31], s50 offen
    s_mov_b64 exec, -1
Lhello69:
    s_lshl_b32 s50, s60, 13
    v_add_u32 v4, s50, v3
    s_mov_b32 s58, 1048576
Llw70:
    ds_read_b32 v5, v1 offset:24
    s_waitcnt lgkmcnt(0)
    v_readfirstlane_b32 s53, v5
    s_nop 0
    s_cmp_ge_u32 s53, 8
    s_cbranch_scc1 Llwx71
    s_sub_u32 s58, s58, 1
    s_cbranch_scc1 Llwx71
    s_sleep 1
    s_branch Llw70
Llwx71:
    ds_read_b128 v[40:43], v4 offset:2816
    ds_read_b128 v[44:47], v4 offset:3840
    ds_read_b128 v[48:51], v4 offset:4864
    ds_read_b128 v[52:55], v4 offset:5888
    ds_read_b128 v[56:59], v4 offset:6912
    ds_read_b128 v[60:63], v4 offset:7936
    ds_read_b128 v[64:67], v4 offset:8960
    ds_read_b128 v[68:71], v4 offset:9984
    s_waitcnt lgkmcnt(7)
    v_lshlrev_b32 v4, 16, v40
    v_and_b32 v5, s54, v40
    v_mul_f32 v32, v24, v4
    v_mul_f32 v33, v24, v5
    v_lshlrev_b32 v4, 16, v41
    v_and_b32 v5, s54, v41
    v_mul_f32 v34, v24, v4
    v_mul_f32 v35, v24, v5
    v_lshlrev_b32 v4, 16, v42
    v_and_b32 v5, s54, v42
    v_mul_f32 v36, v24, v4
    v_mul_f32 v37, v24, v5
    v_lshlrev_b32 v4, 16, v43
    v_and_b32 v5, s54, v43
    v_mul_f32 v38, v24, v4
    v_mul_f32 v39, v24, v5
    s_waitcnt lgkmcnt(6)
    v_lshlrev_b32 v4, 16, v44
    v_and_b32 v5, s54, v44
    v_fmac_f32 v32, v25, v4
    v_fmac_f32 v33, v25, v5
    v_lshlrev_b32 v4, 16, v45
    v_and_b32 v5, s54, v45
    v_fmac_f32 v34, v25, v4
    v_fmac_f32 v35, v25, v5
    v_lshlrev_b32 v4, 16, v46
    v_and_b32 v5, s54, v46
    v_fmac_f32 v36, v25, v4
    v_fmac_f32 v37, v25, v5
    v_lshlrev_b32 v4, 16, v47
    v_and_b32 v5, s54, v47
    v_fmac_f32 v38, v25, v4
    v_fmac_f32 v39, v25, v5
    s_waitcnt lgkmcnt(5)
    v_lshlrev_b32 v4, 16, v48
    v_and_b32 v5, s54, v48
    v_fmac_f32 v32, v26, v4
    v_fmac_f32 v33, v26, v5
    v_lshlrev_b32 v4, 16, v49
    v_and_b32 v5, s54, v49
    v_fmac_f32 v34, v26, v4
    v_fmac_f32 v35, v26, v5
    v_lshlrev_b32 v4, 16, v50
    v_and_b32 v5, s54, v50
    v_fmac_f32 v36, v26, v4
    v_fmac_f32 v37, v26, v5
    v_lshlrev_b32 v4, 16, v51
    v_and_b32 v5, s54, v51
    v_fmac_f32 v38, v26, v4
    v_fmac_f32 v39, v26, v5
    s_waitcnt lgkmcnt(4)
    v_lshlrev_b32 v4, 16, v52
    v_and_b32 v5, s54, v52
    v_fmac_f32 v32, v27, v4
    v_fmac_f32 v33, v27, v5
    v_lshlrev_b32 v4, 16, v53
    v_and_b32 v5, s54, v53
    v_fmac_f32 v34, v27, v4
    v_fmac_f32 v35, v27, v5
    v_lshlrev_b32 v4, 16, v54
    v_and_b32 v5, s54, v54
    v_fmac_f32 v36, v27, v4
    v_fmac_f32 v37, v27, v5
    v_lshlrev_b32 v4, 16, v55
    v_and_b32 v5, s54, v55
    v_fmac_f32 v38, v27, v4
    v_fmac_f32 v39, v27, v5
    s_waitcnt lgkmcnt(3)
    v_lshlrev_b32 v4, 16, v56
    v_and_b32 v5, s54, v56
    v_fmac_f32 v32, v28, v4
    v_fmac_f32 v33, v28, v5
    v_lshlrev_b32 v4, 16, v57
    v_and_b32 v5, s54, v57
    v_fmac_f32 v34, v28, v4
    v_fmac_f32 v35, v28, v5
    v_lshlrev_b32 v4, 16, v58
    v_and_b32 v5, s54, v58
    v_fmac_f32 v36, v28, v4
    v_fmac_f32 v37, v28, v5
    v_lshlrev_b32 v4, 16, v59
    v_and_b32 v5, s54, v59
    v_fmac_f32 v38, v28, v4
    v_fmac_f32 v39, v28, v5
    s_waitcnt lgkmcnt(2)
    v_lshlrev_b32 v4, 16, v60
    v_and_b32 v5, s54, v60
    v_fmac_f32 v32, v29, v4
    v_fmac_f32 v33, v29, v5
    v_lshlrev_b32 v4, 16, v61
    v_and_b32 v5, s54, v61
    v_fmac_f32 v34, v29, v4
    v_fmac_f32 v35, v29, v5
    v_lshlrev_b32 v4, 16, v62
    v_and_b32 v5, s54, v62
    v_fmac_f32 v36, v29, v4
    v_fmac_f32 v37, v29, v5
    v_lshlrev_b32 v4, 16, v63
    v_and_b32 v5, s54, v63
    v_fmac_f32 v38, v29, v4
    v_fmac_f32 v39, v29, v5
    s_waitcnt lgkmcnt(1)
    v_lshlrev_b32 v4, 16, v64
    v_and_b32 v5, s54, v64
    v_fmac_f32 v32, v30, v4
    v_fmac_f32 v33, v30, v5
    v_lshlrev_b32 v4, 16, v65
    v_and_b32 v5, s54, v65
    v_fmac_f32 v34, v30, v4
    v_fmac_f32 v35, v30, v5
    v_lshlrev_b32 v4, 16, v66
    v_and_b32 v5, s54, v66
    v_fmac_f32 v36, v30, v4
    v_fmac_f32 v37, v30, v5
    v_lshlrev_b32 v4, 16, v67
    v_and_b32 v5, s54, v67
    v_fmac_f32 v38, v30, v4
    v_fmac_f32 v39, v30, v5
    s_waitcnt lgkmcnt(0)
    v_lshlrev_b32 v4, 16, v68
    v_and_b32 v5, s54, v68
    v_fmac_f32 v32, v31, v4
    v_fmac_f32 v33, v31, v5
    v_lshlrev_b32 v4, 16, v69
    v_and_b32 v5, s54, v69
    v_fmac_f32 v34, v31, v4
    v_fmac_f32 v35, v31, v5
    v_lshlrev_b32 v4, 16, v70
    v_and_b32 v5, s54, v70
    v_fmac_f32 v36, v31, v4
    v_fmac_f32 v37, v31, v5
    v_lshlrev_b32 v4, 16, v71
    v_and_b32 v5, s54, v71
    v_fmac_f32 v38, v31, v4
    v_fmac_f32 v39, v31, v5
    v_permlane32_swap_b32 v32, v36
    v_permlane32_swap_b32 v33, v37
    v_permlane32_swap_b32 v34, v38
    v_permlane32_swap_b32 v35, v39
    v_add_f32 v32, v32, v36
    v_add_f32 v33, v33, v37
    v_add_f32 v34, v34, v38
    v_add_f32 v35, v35, v39
    s_nop 0
    v_permlane16_swap_b32 v32, v34
    v_permlane16_swap_b32 v33, v35
    v_add_f32 v32, v32, v34
    v_add_f32 v33, v33, v35
    s_nop 0
    v_add_f32_dpp v32, v32, v32 row_ror:8 row_mask:0xf bank_mask:0xf
    v_add_f32_dpp v33, v33, v33 row_ror:8 row_mask:0xf bank_mask:0xf
    s_lshl_b32 s50, s60, 8
    v_and_b32 v4, 7, v0
    v_lshl_add_u32 v4, v4, 5, s50
    v_lshrrev_b32 v5, 4, v0
    v_lshl_add_u32 v4, v5, 3, v4
    v_mov_b32 v5, 1
    s_mov_b32 exec_lo, 0xff00ff
    s_mov_b32 exec_hi, 0xff00ff
    ds_write_b64 v4, v[32:33] offset:1536
    s_mov_b64 exec, 1
    ds_add_u32 v1, v5 offset:12
    s_mov_b64 exec, -1
    s_cmp_eq_u32 s3, 9
    s_cbranch_scc1 Lsw1
    s_cmp_gt_u32 s3, 9
    s_cbranch_scc1 Lsw23
    s_mov_b32 s58, 1048576
Llw72:
    ds_read_b32 v5, v1 offset:12
    s_waitcnt lgkmcnt(0)
    v_readfirstlane_b32 s53, v5
    s_nop 0
    s_cmp_ge_u32 s53, 4
    s_cbranch_scc1 Llwx73
    s_sub_u32 s58, s58, 1
    s_cbranch_scc1 Llwx73
    s_sleep 1
    s_branch Llw72
Llwx73:
    v_and_b32 v8, 31, v0
    v_lshlrev_b32 v8, 2, v8
    buffer_load_dword v9, v8, s[28:31], s67 offen sc1
    s_waitcnt vmcnt(0)
    v_cmp_ne_u32 vcc, s65, v9
    s_nop 0
    s_cmp_eq_u64 vcc, 0
    s_cselect_b32 s66, 2, 1
    v_and_b32 v4, 0xf0, v3
    v_and_b32 v6, 16, v0
    v_lshl_add_u32 v4, v6, 5, v4
    s_mov_b32 s58, 1048576
Llw74:
    ds_read_b32 v5, v1 offset:12
    ds_read_b128 v[40:43], v4 offset:1536
    ds_read_b128 v[44:47], v4 offset:1792
    s_waitcnt lgkmcnt(0)
    v_readfirstlane_b32 s53, v5
    s_nop 0
    s_cmp_ge_u32 s53, 4
    s_cbranch_scc1 Llwx75
    s_sub_u32 s58, s58, 1
    s_cbranch_scc1 Llwx75
    s_sleep 1
    s_branch Llw74
Llwx75:
    v_pk_add_f32 v[40:41], v[40:41], v[44:45]
    v_pk_add_f32 v[42:43], v[42:43], v[46:47]
    s_cmp_ge_u32 s49, 16
    s_cbranch_scc1 Lc1ffn76
    v_mov_b32 v44, v40
    v_mov_b32 v45, v41
    v_mov_b32 v46, v42
    v_mov_b32 v47, v43
    v_permlane16_swap_b32 v40, v44
    v_permlane16_swap_b32 v41, v45
    v_permlane16_swap_b32 v42, v46
    v_permlane16_swap_b32 v43, v47
    v_add_f32 v40, v40, v44
    v_add_f32 v41, v41, v45
    v_add_f32 v42, v42, v46
    v_add_f32 v43, v43, v47
    v_and_b32 v4, 0xf0, v3
    s_lshl_b32 s51, s48, 12
    s_lshl_b32 s52, s62, 11
    s_add_u32 s51, s51, s52
    s_lshl_b32 s52, s61, 8
    s_add_u32 s51, s51, s52
    s_add_u32 s51, s51, 0x1000
    s_mov_b64 exec, 0xffff
    s_branch Lc1join77
Lc1ffn76:
    v_and_b32 v4, 8, v0
    v_lshlrev_b32 v4, 7, v4
    v_and_b32 v5, 0x70, v3
    v_lshl_add_u32 v5, v6, 3, v5
    v_add_u32 v4, v4, v5
    s_lshl_b32 s51, s61, 11
    s_lshl_b32 s52, s62, 8
    s_add_u32 s51, s51, s52
    s_add_u32 s51, s51, 0x10000
    s_mov_b32 exec_lo, -1
    s_mov_b32 exec_hi, 0
Lc1join77:
    v_bfi_b32 v41, s55, v2, v41
    v_bfi_b32 v43, s55, v2, v43
    s_mov_b32 s68, s66
    s_cmp_eq_u32 s68, 2
    s_cbranch_scc1 Lpl78
    buffer_store_dwordx4 v[40:43], v4, s[28:31], s51 offen sc1
    s_branch Lpj79
Lpl78:
    buffer_store_dwordx4 v[40:43], v4, s[28:31], s51 offen
Lpj79:
    s_mov_b64 exec, -1
    s_lshl_b32 s50, s48, 12
    s_add_u32 s50, s50, 0x1000
    s_mov_b32 s58, 1048576
Llw80:
    ds_read_b32 v5, v1 offset:16
    s_waitcnt lgkmcnt(0)
    v_readfirstlane_b32 s53, v5
    s_nop 0
    s_cmp_ge_u32 s53, 16
    s_cbranch_scc1 Llwx81
    s_sub_u32 s58, s58, 1
    s_cbranch_scc1 Llwx81
    s_sleep 1
    s_branch Llw80
Llwx81:
    s_mov_b32 s58, 65536
Lpoll82:
    buffer_load_dwordx4 v[48:51], v3, s[28:31], s50 offen offset:0 sc1
    buffer_load_dwordx4 v[52:55], v3, s[28:31], s50 offen offset:1024 sc1
    buffer_load_dwordx4 v[56:59], v3, s[28:31], s50 offen offset:2048 sc1
    buffer_load_dwordx4 v[60:63], v3, s[28:31], s50 offen offset:3072 sc1
    s_waitcnt vmcnt(3)
    v_xor_b32 v49, v49, v2
    v_xor_b32 v51, v51, v2
    v_or_b32 v4, v49, v51
    s_waitcnt vmcnt(2)
    v_xor_b32 v53, v53, v2
    v_xor_b32 v55, v55, v2
    v_or3_b32 v4, v53, v55, v4
    s_waitcnt vmcnt(1)
    v_xor_b32 v57, v57, v2
    v_xor_b32 v59, v59, v2
    v_or3_b32 v4, v57, v59, v4
    s_waitcnt vmcnt(0)
    v_xor_b32 v61, v61, v2
    v_xor_b32 v63, v63, v2
    v_or3_b32 v4, v61, v63, v4
    v_and_b32 v4, s55, v4
    v_cmp_ne_u32 vcc, 0, v4
    s_cbranch_vccz Lpollx83
    s_sub_u32 s58, s58, 1
    s_cbranch_scc0 Lpoll82
Lpollx83:
    s_nop 0
    v_pk_add_f32 v[48:49], v[48:49], v[56:57]
    v_pk_add_f32 v[50:51], v[50:51], v[58:59]
    v_pk_add_f32 v[52:53], v[52:53], v[60:61]
    v_pk_add_f32 v[54:55], v[54:55], v[62:63]
    v_cvt_pk_bf16_f32 v16, v48, v49
    v_cvt_pk_bf16_f32 v17, v50, v51
    v_cvt_pk_bf16_f32 v18, v52, v53
    v_cvt_pk_bf16_f32 v19, v54, v55
    v_lshlrev_b32 v4, 3, v0
    v_mov_b32 v5, 1
    ds_write_b64 v4, v[16:17] offset:512
    ds_write_b64 v4, v[18:19] offset:1024
    s_waitcnt lgkmcnt(0)
    ds_write_b32 v1, v5 offset:0
    s_cmp_eq_u32 s66, 2
    s_cbranch_scc1 Lknown84
    v_and_b32 v8, 31, v0
    v_lshlrev_b32 v8, 2, v8
    buffer_load_dword v9, v8, s[28:31], s67 offen sc1
    s_waitcnt vmcnt(0)
    v_cmp_ne_u32 vcc, s65, v9
    s_nop 0
    s_cmp_eq_u64 vcc, 0
    s_cselect_b32 s66, 2, 1
Lknown84:
    v_and_b32 v4, 28, v0
    v_lshlrev_b32 v4, 3, v4
    v_and_b32 v6, 3, v0
    v_lshl_add_u32 v4, v6, 2, v4
    s_mov_b32 s58, 1048576
Llw85:
    ds_read_b32 v5, v1 offset:4
    ds_read2_b32 v[16:17], v4 offset0:16 offset1:20
    s_waitcnt lgkmcnt(0)
    v_readfirstlane_b32 s53, v5
    s_nop 0
    s_cmp_ge_u32 s53, 8
    s_cbranch_scc1 Llwx86
    s_sub_u32 s58, s58, 1
    s_cbranch_scc1 Llwx86
    s_sleep 1
    s_branch Llw85
Llwx86:
    s_mov_b32 s52, 0x3fb8aa3b
    v_mov_b32 v18, v16
    s_nop 1
    v_max_f32_dpp v18, v18, v18 row_ror:4 row_mask:0xf bank_mask:0xf
    s_nop 1
    v_max_f32_dpp v18, v18, v18 row_ror:8 row_mask:0xf bank_mask:0xf
    v_mov_b32 v4, v18
    s_nop 1
    v_permlane16_swap_b32 v18, v4
    v_max_f32 v18, v18, v4
    v_sub_f32 v19, v16, v18
    v_mul_f32 v19, s52, v19
    v_exp_f32 v19, v19
    s_nop 0
    v_mul_f32 v19, v19, v17
    s_nop 1
    v_add_f32_dpp v19, v19, v19 row_ror:4 row_mask:0xf bank_mask:0xf
    s_nop 1
    v_add_f32_dpp v19, v19, v19 row_ror:8 row_mask:0xf bank_mask:0xf
    v_mov_b32 v4, v19
    s_nop 1
    v_permlane16_swap_b32 v19, v4
    v_add_f32 v19, v19, v4
    s_mov_b32 s55, 0x3ff
    v_mov_b32 v2, s59
    v_and_b32 v2, s55, v2
    v_bfi_b32 v18, s55, v2, v18
    v_bfi_b32 v19, s55, v2, v19
    v_lshlrev_b32 v4, 3, v0
    s_lshl_b32 s50, s48, 10
    s_add_u32 s50, s50, 0x9000
    s_lshl_b32 s51, s49, 5
    s_add_u32 s51, s51, s50
    s_mov_b64 exec, 15
    s_cmp_eq_u32 s66, 2
    s_cbranch_scc1 Lpl87
    buffer_store_dwordx2 v[18:19], v4, s[28:31], s51 offen sc1
    s_branch Lpj88
Lpl87:
    buffer_store_dwordx2 v[18:19], v4, s[28:31], s51 offen
Lpj88:
    s_mov_b64 exec, -1
    s_mov_b32 s58, 1048576
Llw89:
    ds_read_b32 v5, v1 offset:16
    s_waitcnt lgkmcnt(0)
    v_readfirstlane_b32 s53, v5
    s_nop 0
    s_cmp_ge_u32 s53, 56
    s_cbranch_scc1 Llwx90
    s_sub_u32 s58, s58, 1
    s_cbranch_scc1 Llwx90
    s_sleep 1
    s_branch Llw89
Llwx90:
    s_mov_b32 s58, 65536
Lpoll91:
    buffer_load_dwordx2 v[40:41], v4, s[28:31], s50 offen sc1
    buffer_load_dwordx2 v[42:43], v4, s[28:31], s50 offen offset:512 sc1
    s_waitcnt vmcnt(1)
    v_xor_b32 v40, v40, v2
    v_xor_b32 v41, v41, v2
    v_or_b32 v5, v40, v41
    s_waitcnt vmcnt(0)
    v_xor_b32 v42, v42, v2
    v_xor_b32 v43, v43, v2
    v_or3_b32 v5, v42, v43, v5
    v_and_b32 v5, s55, v5
    v_cmp_ne_u32 vcc, 0, v5
    s_cbranch_vccz Lpollx92
    s_sub_u32 s58, s58, 1
    s_cbranch_scc0 Lpoll91
Lpollx92:
    s_nop 0
    v_and_b32 v40, s54, v40
    v_and_b32 v42, s54, v42
    v_max_f32 v18, v40, v42
    s_nop 1
    v_max_f32_dpp v18, v18, v18 row_ror:4 row_mask:0xf bank_mask:0xf
    s_nop 1
    v_max_f32_dpp v18, v18, v18 row_ror:8 row_mask:0xf bank_mask:0xf
    v_mov_b32 v4, v18
    s_nop 1
    v_permlane16_swap_b32 v18, v4
    v_max_f32 v18, v18, v4
    v_mov_b32 v4, v18
    s_nop 1
    v_permlane32_swap_b32 v18, v4
    v_max_f32 v18, v18, v4
    v_sub_f32 v40, v40, v18
    v_sub_f32 v42, v42, v18
    v_sub_f32 v16, v16, v18
    v_mul_f32 v40, s52, v40
    v_mul_f32 v42, s52, v42
    v_mul_f32 v16, s52, v16
    v_exp_f32 v40, v40
    v_exp_f32 v42, v42
    v_exp_f32 v16, v16
    v_mul_f32 v19, v40, v41
    v_fmac_f32 v19, v42, v43
    s_nop 1
    v_add_f32_dpp v19, v19, v19 row_ror:4 row_mask:0xf bank_mask:0xf
    s_nop 1
    v_add_f32_dpp v19, v19, v19 row_ror:8 row_mask:0xf bank_mask:0xf
    v_mov_b32 v4, v19
    s_nop 1
    v_permlane16_swap_b32 v19, v4
    v_add_f32 v19, v19, v4
    v_mov_b32 v4, v19
    s_nop 1
    v_permlane32_swap_b32 v19, v4
    v_add_f32 v19, v19, v4
    v_rcp_f32 v19, v19
    s_nop 0
    v_mul_f32 v16, v16, v19
    v_and_b32 v4, 31, v0
    v_lshlrev_b32 v4, 2, v4
    v_mov_b32 v5, s66
    ds_write_b32 v4, v16 offset:320
    s_waitcnt lgkmcnt(0)
    ds_write_b32 v1, v5 offset:8
    s_waitcnt lgkmcnt(0)
    s_endpgm
Lsw23:
    s_and_b32 s68, s3, 1
    s_lshl_b32 s69, s48, 3
    s_lshr_b32 s51, s49, 2
    s_add_u32 s69, s69, s51
    s_and_b32 s70, s49, 3
    s_lshl_b32 s70, s70, 1
    s_add_u32 s70, s70, s68
    s_mul_i32 s73, s68, 12288
    v_lshrrev_b32 v4, 4, v0
    v_lshl_add_u32 v4, v4, 10, s73
    v_bfe_u32 v6, v0, 2, 2
    v_lshl_add_u32 v4, v6, 7, v4
    v_and_b32 v6, 3, v0
    v_lshl_add_u32 v4, v6, 3, v4
    s_lshl_b32 s50, s48, 16
    s_add_u32 s50, s50, 0x20000
    s_lshl_b32 s71, s49, 11
    s_add_u32 s71, s71, s50
    s_lshr_b32 s51, s49, 2
    s_lshl_b32 s51, s51, 8
    s_add_u32 s60, s50, s51
    s_add_u32 s61, s60, 8192
    s_add_u32 s62, s60, 16384
    s_add_u32 s63, s60, 24576
    s_add_u32 s64, s60, 32768
    s_add_u32 s65, s60, 40960
    s_add_u32 s66, s60, 49152
    s_add_u32 s67, s60, 57344
    v_lshrrev_b32 v10, 4, v0
    v_and_b32 v6, 0xf0, v3
    v_lshl_add_u32 v10, v10, 11, v6
    s_lshl_b32 s72, s70, 15
    s_lshl_b32 s51, s69, 7
    s_add_u32 s72, s72, s51
    s_add_u32 s72, s72, 0xa0000
    v_and_b32 v11, 3, v0
    v_lshlrev_b32 v11, 13, v11
    v_and_b32 v6, 4, v0
    v_lshl_add_u32 v11, v6, 4, v11
    v_and_b32 v12, 48, v0
    v_add_u32 v11, v11, v12
    v_lshrrev_b32 v5, 3, v0
    v_and_b32 v6, 0x70, v3
    v_lshl_add_u32 v15, v5, 10, v6
    s_mul_i32 s51, s68, 1152
    v_mul_u32_u24 v5, 144, v5
    v_add3_u32 v14, v5, v6, s51
    s_lshl_b32 s44, s48, 19
    s_lshr_b32 s51, s49, 2
    s_lshl_b32 s51, s51, 14
    s_add_u32 s44, s44, s51
    s_lshl_b32 s51, s70, 7
    s_add_u32 s44, s44, s51
    s_lshl_b32 s45, s69, 15
    s_add_u32 s45, s45, s51
    s_add_u32 s73, s73, 21248
    s_mov_b32 s32, s12
    s_mov_b32 s33, s13
    s_mov_b32 s34, 0x400000
    s_mov_b32 s35, 0x20000
    s_mov_b32 s36, s20
    s_mov_b32 s37, s21
    s_mov_b32 s38, 0x1c0000
    s_mov_b32 s39, 0x20000
    s_lshl_b32 s50, s2, 5
    s_lshl_b32 s51, s68, 4
    s_add_u32 s50, s50, s51
    v_and_b32 v67, 1, v0
    v_lshl_add_u32 v67, v67, 3, s50
    v_lshrrev_b32 v5, 4, v0
    v_lshl_add_u32 v67, v5, 1, v67
    s_mov_b32 s6, 1024
    s_mov_b32 s7, 0x20000
    buffer_load_ushort v66, v67, s[4:7], 0 offen
    s_cmp_lg_u32 s68, 0
    s_cbranch_scc1 Lctlx94
    s_lshl_b32 s50, s48, 7
    v_and_b32 v29, 31, v0
    v_lshlrev_b32 v29, 2, v29
    s_add_u32 s50, s50, 0xb000
    s_lshl_b32 s51, s49, 2
    s_add_u32 s51, s51, s50
    s_lshl_b32 s40, s59, 16
    ds_read_b32 v25, v1 offset:32
    s_mov_b32 s58, 4096
Lctl93:
    ds_read_b32 v24, v1 offset:32
    s_waitcnt lgkmcnt(0)
    v_or_b32 v26, s40, v24
    v_readfirstlane_b32 s52, v24
    s_mov_b64 exec, 1
    buffer_store_dword v26, v1, s[28:31], s51 offen
    s_mov_b64 exec, -1
    s_cmp_ge_u32 s52, 480
    s_cbranch_scc1 Lctlx94
    s_sub_u32 s58, s58, 1
    s_cbranch_scc1 Lctlx94
    buffer_load_dword v27, v29, s[28:31], s50 offen sc1
    v_add_u32 v25, v25, v24
    v_cvt_f32_u32 v25, v25
    s_waitcnt vmcnt(0)
    ds_read_b32 v28, v1 offset:32
    v_xor_b32 v27, s40, v27
    v_cmp_gt_u32 vcc, 0x10000, v27
    v_cvt_f32_u32 v27, v27
    s_nop 0
    v_cndmask_b32 v27, 0, v27, vcc
    s_bcnt1_i32_b32 s52, vcc_lo
    s_nop 0
    v_add_f32_dpp v27, v27, v27 row_ror:8 row_mask:0xf bank_mask:0xf
    s_nop 1
    v_add_f32_dpp v27, v27, v27 row_ror:4 row_mask:0xf bank_mask:0xf
    s_nop 1
    v_add_f32_dpp v27, v27, v27 row_ror:2 row_mask:0xf bank_mask:0xf
    s_nop 1
    v_add_f32_dpp v27, v27, v27 row_ror:1 row_mask:0xf bank_mask:0xf
    v_mov_b32 v26, v27
    s_nop 1
    v_permlane16_swap_b32 v27, v26
    v_add_f32 v27, v27, v26
    v_cvt_f32_u32 v26, s52
    v_rcp_f32 v26, v26
    s_waitcnt lgkmcnt(0)
    s_cmp_lt_u32 s52, 24
    s_cbranch_scc1 Lctls95
    v_mul_f32 v27, v27, v26
    v_fma_f32 v27, v25, -0.5, v27
    v_lshrrev_b32 v28, 3, v28
    v_add_u32 v28, 3, v28
    v_mul_f32 v25, 0x3f000000, v27
    v_min_f32 v25, 0x40a00000, v25
    v_max_f32 v25, 0, v25
    v_cmp_lt_f32 vcc, 0x0, v27
    v_cvt_u32_f32 v25, v25
    v_add_u32 v25, v25, v28
    v_cndmask_b32 v26, 0, v25, vcc
    s_mov_b64 exec, 1
    ds_write_b64 v1, v[26:27] offset:40
    s_mov_b64 exec, -1
Lctls95:
    v_mov_b32 v25, v24
    s_branch Lctl93
Lctlx94:
    s_mov_b32 s58, 1048576
Llw96:
    ds_read_b32 v6, v1 offset:20
    ds_read_b128 v[56:59], v12 offset:448
    s_waitcnt lgkmcnt(0)
    v_readfirstlane_b32 s53, v6
    s_nop 0
    s_cmp_ge_u32 s53, 1
    s_cbranch_scc1 Llwx97
    s_sub_u32 s58, s58, 1
    s_cbranch_scc1 Llwx97
    s_sleep 1
    s_branch Llw96
Llwx97:
    s_mov_b32 s58, 1048576
Llw98:
    ds_read_b32 v6, v1 offset:8
    ds_read_b128 v[120:123], v1 offset:320
    ds_read_b128 v[124:127], v1 offset:336
    ds_read_b128 v[128:131], v1 offset:352
    ds_read_b128 v[132:135], v1 offset:368
    ds_read_b128 v[136:139], v1 offset:384
    ds_read_b128 v[140:143], v1 offset:400
    ds_read_b128 v[144:147], v1 offset:416
    ds_read_b128 v[148:151], v1 offset:432
    s_waitcnt lgkmcnt(0)
    v_readfirstlane_b32 s53, v6
    s_nop 0
    s_cmp_ge_u32 s53, 1
    s_cbranch_scc1 Llwx99
    s_sub_u32 s58, s58, 1
    s_cbranch_scc1 Llwx99
    s_sleep 1
    s_branch Llw98
Llwx99:
    s_mov_b32 s74, s53
    s_lshl_b32 s50, s68, 10
    v_add_u32 v3, s50, v3
    s_lshl_b32 s50, s68, 7
    v_add_u32 v13, s50, v12
    v_lshl_add_u32 v5, v0, 1, s50
    s_mov_b32 s58, 1048576
Llw100:
    ds_read_b32 v6, v1 offset:28
    s_waitcnt lgkmcnt(0)
    v_readfirstlane_b32 s53, v6
    s_nop 0
    s_cmp_ge_u32 s53, 8
    s_cbranch_scc1 Llwx101
    s_sub_u32 s58, s58, 1
    s_cbranch_scc1 Llwx101
    s_branch Llw100
Llwx101:
    s_add_u32 m0, s73, 8192
    s_nop 0
    buffer_load_dwordx4 v15, s[36:39], s45 offen nt lds
    s_add_u32 s45, s45, 8192
    s_add_u32 m0, s73, 9216
    s_nop 0
    buffer_load_dwordx4 v15, s[36:39], s45 offen nt lds
    s_add_u32 s45, s45, 8192
    s_add_u32 m0, s73, 10240
    s_nop 0
    buffer_load_dwordx4 v15, s[36:39], s45 offen nt lds
    s_add_u32 s45, s45, 8192
    s_add_u32 m0, s73, 11264
    s_nop 0
    buffer_load_dwordx4 v15, s[36:39], s45 offen nt lds
    s_add_u32 s45, s45, 8192
    s_add_u32 m0, s73, 0
    s_nop 0
    buffer_load_dwordx4 v15, s[32:35], s44 offen nt lds
    s_add_u32 s44, s44, 0x2000
    s_add_u32 m0, s73, 1024
    s_nop 0
    buffer_load_dwordx4 v15, s[32:35], s44 offen nt lds
    s_add_u32 s44, s44, 0x1e000
    s_add_u32 m0, s73, 2048
    s_nop 0
    buffer_load_dwordx4 v15, s[32:35], s44 offen nt lds
    s_add_u32 s44, s44, 0x2000
    s_add_u32 m0, s73, 3072
    s_nop 0
    buffer_load_dwordx4 v15, s[32:35], s44 offen nt lds
    s_add_u32 s44, s44, 0x1e000
    s_add_u32 m0, s73, 4096
    s_nop 0
    buffer_load_dwordx4 v15, s[32:35], s44 offen nt lds
    s_add_u32 s44, s44, 0x2000
    s_add_u32 m0, s73, 5120
    s_nop 0
    buffer_load_dwordx4 v15, s[32:35], s44 offen nt lds
    s_add_u32 s44, s44, 0x1e000
    s_add_u32 m0, s73, 6144
    s_nop 0
    buffer_load_dwordx4 v15, s[32:35], s44 offen nt lds
    s_add_u32 s44, s44, 0x2000
    s_add_u32 m0, s73, 7168
    s_nop 0
    buffer_load_dwordx4 v15, s[32:35], s44 offen nt lds
    s_add_u32 s44, s44, 0x1e000
    v_mov_b32 v6, 1
    s_barrier
    ds_read_b128 v[24:27], v14 offset:2816
    ds_read_b128 v[28:31], v14 offset:5120
    ds_read_b128 v[32:35], v14 offset:7424
    ds_read_b128 v[36:39], v14 offset:9728
    ds_read_b128 v[40:43], v14 offset:12032
    ds_read_b128 v[44:47], v14 offset:14336
    ds_read_b128 v[48:51], v14 offset:16640
    ds_read_b128 v[52:55], v14 offset:18944
    s_waitcnt lgkmcnt(7)
    v_pk_mul_f32 v[20:21], v[24:25], v[120:121]
    v_pk_mul_f32 v[22:23], v[26:27], v[122:123]
    s_waitcnt lgkmcnt(6)
    v_pk_fma_f32 v[20:21], v[28:29], v[124:125], v[20:21]
    v_pk_fma_f32 v[22:23], v[30:31], v[126:127], v[22:23]
    s_waitcnt lgkmcnt(5)
    v_pk_fma_f32 v[20:21], v[32:33], v[128:129], v[20:21]
    v_pk_fma_f32 v[22:23], v[34:35], v[130:131], v[22:23]
    s_waitcnt lgkmcnt(4)
    v_pk_fma_f32 v[20:21], v[36:37], v[132:133], v[20:21]
    v_pk_fma_f32 v[22:23], v[38:39], v[134:135], v[22:23]
    s_waitcnt lgkmcnt(3)
    v_pk_fma_f32 v[20:21], v[40:41], v[136:137], v[20:21]
    v_pk_fma_f32 v[22:23], v[42:43], v[138:139], v[22:23]
    s_waitcnt lgkmcnt(2)
    v_pk_fma_f32 v[20:21], v[44:45], v[140:141], v[20:21]
    v_pk_fma_f32 v[22:23], v[46:47], v[142:143], v[22:23]
    s_waitcnt lgkmcnt(1)
    v_pk_fma_f32 v[20:21], v[48:49], v[144:145], v[20:21]
    v_pk_fma_f32 v[22:23], v[50:51], v[146:147], v[22:23]
    s_waitcnt lgkmcnt(0)
    v_pk_fma_f32 v[20:21], v[52:53], v[148:149], v[20:21]
    v_pk_fma_f32 v[22:23], v[54:55], v[150:151], v[22:23]
    s_cmp_eq_u32 s74, 2
    v_bfi_b32 v21, s55, v2, v21
    v_bfi_b32 v23, s55, v2, v23
    s_cbranch_scc1 Lh1l102
    buffer_store_dwordx4 v[20:23], v3, s[28:31], s71 offen sc1
    s_branch Lh1j103
Lh1l102:
    buffer_store_dwordx4 v[20:23], v3, s[28:31], s71 offen
Lh1j103:
    s_cmp_lg_u32 s68, 0
    s_cbranch_scc1 Lsolo1104
    buffer_load_dwordx4 v[24:27], v10, s[28:31], s60 offen sc1
    buffer_load_dwordx4 v[28:31], v10, s[28:31], s61 offen sc1
    buffer_load_dwordx4 v[32:35], v10, s[28:31], s62 offen sc1
    buffer_load_dwordx4 v[36:39], v10, s[28:31], s63 offen sc1
    buffer_load_dwordx4 v[40:43], v10, s[28:31], s64 offen sc1
    buffer_load_dwordx4 v[44:47], v10, s[28:31], s65 offen sc1
    buffer_load_dwordx4 v[48:51], v10, s[28:31], s66 offen sc1
    buffer_load_dwordx4 v[52:55], v10, s[28:31], s67 offen sc1
    s_waitcnt vmcnt(16)
    ds_read_b64_tr_b16 v[104:105], v4 offset:29440
    ds_read_b64_tr_b16 v[106:107], v4 offset:29952
    ds_read_b64_tr_b16 v[108:109], v4 offset:29472
    ds_read_b64_tr_b16 v[110:111], v4 offset:29984
    ds_read_b64_tr_b16 v[112:113], v4 offset:29504
    ds_read_b64_tr_b16 v[114:115], v4 offset:30016
    ds_read_b64_tr_b16 v[116:117], v4 offset:29536
    ds_read_b64_tr_b16 v[118:119], v4 offset:30048
    s_waitcnt lgkmcnt(0)
    v_mfma_f32_16x16x32_bf16 v[152:155], v[104:107], v[56:59], 0
    v_mfma_f32_16x16x32_bf16 v[156:159], v[108:111], v[56:59], 0
    v_mfma_f32_16x16x32_bf16 v[160:163], v[112:115], v[56:59], 0
    v_mfma_f32_16x16x32_bf16 v[164:167], v[116:119], v[56:59], 0
    s_mov_b32 exec_lo, 0x100010
    s_mov_b32 exec_hi, 0x100010
    s_nop 2
    v_mov_b32 v16, v152
    v_bfi_b32 v17, s55, v2, v153
    v_mov_b32 v18, v154
    v_bfi_b32 v19, s55, v2, v155
    s_lshl_b64 exec, exec, 1
    v_mov_b32 v16, v156
    v_bfi_b32 v17, s55, v2, v157
    v_mov_b32 v18, v158
    v_bfi_b32 v19, s55, v2, v159
    s_lshl_b64 exec, exec, 1
    v_mov_b32 v16, v160
    v_bfi_b32 v17, s55, v2, v161
    v_mov_b32 v18, v162
    v_bfi_b32 v19, s55, v2, v163
    s_lshl_b64 exec, exec, 1
    v_mov_b32 v16, v164
    v_bfi_b32 v17, s55, v2, v165
    v_mov_b32 v18, v166
    v_bfi_b32 v19, s55, v2, v167
    s_mov_b64 exec, -1
    s_waitcnt vmcnt(12)
    ds_read_b64_tr_b16 v[72:73], v4 offset:21248
    ds_read_b64_tr_b16 v[74:75], v4 offset:21760
    ds_read_b64_tr_b16 v[80:81], v4 offset:21280
    ds_read_b64_tr_b16 v[82:83], v4 offset:21792
    ds_read_b64_tr_b16 v[88:89], v4 offset:21312
    ds_read_b64_tr_b16 v[90:91], v4 offset:21824
    ds_read_b64_tr_b16 v[96:97], v4 offset:21344
    ds_read_b64_tr_b16 v[98:99], v4 offset:21856
    s_waitcnt vmcnt(8)
    ds_read_b64_tr_b16 v[76:77], v4 offset:25344
    ds_read_b64_tr_b16 v[78:79], v4 offset:25856
    ds_read_b64_tr_b16 v[84:85], v4 offset:25376
    ds_read_b64_tr_b16 v[86:87], v4 offset:25888
    ds_read_b64_tr_b16 v[92:93], v4 offset:25408
    ds_read_b64_tr_b16 v[94:95], v4 offset:25920
    ds_read_b64_tr_b16 v[100:101], v4 offset:25440
    ds_read_b64_tr_b16 v[102:103], v4 offset:25952
    s_mov_b32 s58, 65536
Lpp106:
    buffer_load_dwordx4 v[104:107], v10, s[28:31], s60 offen sc1
    buffer_load_dwordx4 v[108:111], v10, s[28:31], s61 offen sc1
    buffer_load_dwordx4 v[112:115], v10, s[28:31], s62 offen sc1
    buffer_load_dwordx4 v[116:119], v10, s[28:31], s63 offen sc1
    buffer_load_dwordx4 v[124:127], v10, s[28:31], s64 offen sc1
    buffer_load_dwordx4 v[128:131], v10, s[28:31], s65 offen sc1
    buffer_load_dwordx4 v[132:135], v10, s[28:31], s66 offen sc1
    buffer_load_dwordx4 v[136:139], v10, s[28:31], s67 offen sc1
    s_waitcnt vmcnt(15)
    v_xor_b32 v25, v25, v2
    v_xor_b32 v27, v27, v2
    v_or_b32 v7, v25, v27
    s_waitcnt vmcnt(14)
    v_xor_b32 v29, v29, v2
    v_xor_b32 v31, v31, v2
    v_or3_b32 v7, v29, v31, v7
    v_pk_add_f32 v[20:21], v[24:25], v[28:29]
    v_pk_add_f32 v[22:23], v[26:27], v[30:31]
    s_waitcnt vmcnt(13)
    v_xor_b32 v33, v33, v2
    v_xor_b32 v35, v35, v2
    v_or3_b32 v7, v33, v35, v7
    v_pk_add_f32 v[20:21], v[20:21], v[32:33]
    v_pk_add_f32 v[22:23], v[22:23], v[34:35]
    s_waitcnt vmcnt(12)
    v_xor_b32 v37, v37, v2
    v_xor_b32 v39, v39, v2
    v_or3_b32 v7, v37, v39, v7
    v_pk_add_f32 v[20:21], v[20:21], v[36:37]
    v_pk_add_f32 v[22:23], v[22:23], v[38:39]
    s_waitcnt vmcnt(11)
    v_xor_b32 v41, v41, v2
    v_xor_b32 v43, v43, v2
    v_or3_b32 v7, v41, v43, v7
    v_pk_add_f32 v[20:21], v[20:21], v[40:41]
    v_pk_add_f32 v[22:23], v[22:23], v[42:43]
    s_waitcnt vmcnt(10)
    v_xor_b32 v45, v45, v2
    v_xor_b32 v47, v47, v2
    v_or3_b32 v7, v45, v47, v7
    v_pk_add_f32 v[20:21], v[20:21], v[44:45]
    v_pk_add_f32 v[22:23], v[22:23], v[46:47]
    s_waitcnt vmcnt(9)
    v_xor_b32 v49, v49, v2
    v_xor_b32 v51, v51, v2
    v_or3_b32 v7, v49, v51, v7
    v_pk_add_f32 v[20:21], v[20:21], v[48:49]
    v_pk_add_f32 v[22:23], v[22:23], v[50:51]
    s_waitcnt vmcnt(8)
    v_xor_b32 v53, v53, v2
    v_xor_b32 v55, v55, v2
    v_or3_b32 v7, v53, v55, v7
    v_pk_add_f32 v[20:21], v[20:21], v[52:53]
    v_pk_add_f32 v[22:23], v[22:23], v[54:55]
    v_and_b32 v7, s55, v7
    v_cmp_ne_u32 vcc, 0, v7
    s_cbranch_vccz Lppx107
    buffer_load_dwordx4 v[24:27], v10, s[28:31], s60 offen sc1
    buffer_load_dwordx4 v[28:31], v10, s[28:31], s61 offen sc1
    buffer_load_dwordx4 v[32:35], v10, s[28:31], s62 offen sc1
    buffer_load_dwordx4 v[36:39], v10, s[28:31], s63 offen sc1
    buffer_load_dwordx4 v[40:43], v10, s[28:31], s64 offen sc1
    buffer_load_dwordx4 v[44:47], v10, s[28:31], s65 offen sc1
    buffer_load_dwordx4 v[48:51], v10, s[28:31], s66 offen sc1
    buffer_load_dwordx4 v[52:55], v10, s[28:31], s67 offen sc1
    s_waitcnt vmcnt(15)
    v_xor_b32 v105, v105, v2
    v_xor_b32 v107, v107, v2
    v_or_b32 v7, v105, v107
    s_waitcnt vmcnt(14)
    v_xor_b32 v109, v109, v2
    v_xor_b32 v111, v111, v2
    v_or3_b32 v7, v109, v111, v7
    v_pk_add_f32 v[20:21], v[104:105], v[108:109]
    v_pk_add_f32 v[22:23], v[106:107], v[110:111]
    s_waitcnt vmcnt(13)
    v_xor_b32 v113, v113, v2
    v_xor_b32 v115, v115, v2
    v_or3_b32 v7, v113, v115, v7
    v_pk_add_f32 v[20:21], v[20:21], v[112:113]
    v_pk_add_f32 v[22:23], v[22:23], v[114:115]
    s_waitcnt vmcnt(12)
    v_xor_b32 v117, v117, v2
    v_xor_b32 v119, v119, v2
    v_or3_b32 v7, v117, v119, v7
    v_pk_add_f32 v[20:21], v[20:21], v[116:117]
    v_pk_add_f32 v[22:23], v[22:23], v[118:119]
    s_waitcnt vmcnt(11)
    v_xor_b32 v125, v125, v2
    v_xor_b32 v127, v127, v2
    v_or3_b32 v7, v125, v127, v7
    v_pk_add_f32 v[20:21], v[20:21], v[124:125]
    v_pk_add_f32 v[22:23], v[22:23], v[126:127]
    s_waitcnt vmcnt(10)
    v_xor_b32 v129, v129, v2
    v_xor_b32 v131, v131, v2
    v_or3_b32 v7, v129, v131, v7
    v_pk_add_f32 v[20:21], v[20:21], v[128:129]
    v_pk_add_f32 v[22:23], v[22:23], v[130:131]
    s_waitcnt vmcnt(9)
    v_xor_b32 v133, v133, v2
    v_xor_b32 v135, v135, v2
    v_or3_b32 v7, v133, v135, v7
    v_pk_add_f32 v[20:21], v[20:21], v[132:133]
    v_pk_add_f32 v[22:23], v[22:23], v[134:135]
    s_waitcnt vmcnt(8)
    v_xor_b32 v137, v137, v2
    v_xor_b32 v139, v139, v2
    v_or3_b32 v7, v137, v139, v7
    v_pk_add_f32 v[20:21], v[20:21], v[136:137]
    v_pk_add_f32 v[22:23], v[22:23], v[138:139]
    v_and_b32 v7, s55, v7
    v_cmp_ne_u32 vcc, 0, v7
    s_cbranch_vccz Lppx107
    s_sub_u32 s58, s58, 1
    s_cbranch_scc0 Lpp106
Lppx107:
    v_permlane32_swap_b32 v20, v22
    v_permlane32_swap_b32 v21, v23
    v_add_f32 v20, v20, v22
    v_add_f32 v21, v21, v23
    s_nop 1
    v_permlane16_swap_b32 v20, v21
    v_add_f32 v20, v20, v21
    v_cvt_pk_bf16_f32 v20, v20, v20
    ds_write_b16 v5, v20 offset:2560
    s_mov_b64 exec, 1
    ds_write_b32 v1, v6 offset:48
    s_mov_b64 exec, -1
    ds_read_b128 v[56:59], v12 offset:2560
    ds_read_b128 v[60:63], v12 offset:2624
    s_branch Lsolo2105
Lsolo1104:
    s_waitcnt vmcnt(8)
    ds_read_b64_tr_b16 v[104:105], v4 offset:29440
    ds_read_b64_tr_b16 v[106:107], v4 offset:29952
    ds_read_b64_tr_b16 v[108:109], v4 offset:29472
    ds_read_b64_tr_b16 v[110:111], v4 offset:29984
    ds_read_b64_tr_b16 v[112:113], v4 offset:29504
    ds_read_b64_tr_b16 v[114:115], v4 offset:30016
    ds_read_b64_tr_b16 v[116:117], v4 offset:29536
    ds_read_b64_tr_b16 v[118:119], v4 offset:30048
    s_waitcnt lgkmcnt(0)
    v_mfma_f32_16x16x32_bf16 v[152:155], v[104:107], v[56:59], 0
    v_mfma_f32_16x16x32_bf16 v[156:159], v[108:111], v[56:59], 0
    v_mfma_f32_16x16x32_bf16 v[160:163], v[112:115], v[56:59], 0
    v_mfma_f32_16x16x32_bf16 v[164:167], v[116:119], v[56:59], 0
    s_mov_b32 exec_lo, 0x100010
    s_mov_b32 exec_hi, 0x100010
    s_nop 2
    v_mov_b32 v16, v152
    v_bfi_b32 v17, s55, v2, v153
    v_mov_b32 v18, v154
    v_bfi_b32 v19, s55, v2, v155
    s_lshl_b64 exec, exec, 1
    v_mov_b32 v16, v156
    v_bfi_b32 v17, s55, v2, v157
    v_mov_b32 v18, v158
    v_bfi_b32 v19, s55, v2, v159
    s_lshl_b64 exec, exec, 1
    v_mov_b32 v16, v160
    v_bfi_b32 v17, s55, v2, v161
    v_mov_b32 v18, v162
    v_bfi_b32 v19, s55, v2, v163
    s_lshl_b64 exec, exec, 1
    v_mov_b32 v16, v164
    v_bfi_b32 v17, s55, v2, v165
    v_mov_b32 v18, v166
    v_bfi_b32 v19, s55, v2, v167
    s_mov_b64 exec, -1
    s_waitcnt vmcnt(4)
    ds_read_b64_tr_b16 v[72:73], v4 offset:21248
    ds_read_b64_tr_b16 v[74:75], v4 offset:21760
    ds_read_b64_tr_b16 v[80:81], v4 offset:21280
    ds_read_b64_tr_b16 v[82:83], v4 offset:21792
    ds_read_b64_tr_b16 v[88:89], v4 offset:21312
    ds_read_b64_tr_b16 v[90:91], v4 offset:21824
    ds_read_b64_tr_b16 v[96:97], v4 offset:21344
    ds_read_b64_tr_b16 v[98:99], v4 offset:21856
    s_waitcnt vmcnt(0)
    ds_read_b64_tr_b16 v[76:77], v4 offset:25344
    ds_read_b64_tr_b16 v[78:79], v4 offset:25856
    ds_read_b64_tr_b16 v[84:85], v4 offset:25376
    ds_read_b64_tr_b16 v[86:87], v4 offset:25888
    ds_read_b64_tr_b16 v[92:93], v4 offset:25408
    ds_read_b64_tr_b16 v[94:95], v4 offset:25920
    ds_read_b64_tr_b16 v[100:101], v4 offset:25440
    ds_read_b64_tr_b16 v[102:103], v4 offset:25952
    s_mov_b32 s58, 1048576
Llw108:
    ds_read_b32 v6, v1 offset:48
    ds_read_b128 v[56:59], v12 offset:2560
    ds_read_b128 v[60:63], v12 offset:2624
    s_waitcnt lgkmcnt(0)
    v_readfirstlane_b32 s53, v6
    s_nop 0
    s_cmp_ge_u32 s53, 1
    s_cbranch_scc1 Llwx109
    s_sub_u32 s58, s58, 1
    s_cbranch_scc1 Llwx109
    s_branch Llw108
Llwx109:
Lsolo2105:
    s_mov_b32 exec_lo, 0x10001
    s_mov_b32 exec_hi, 0x10001
    s_waitcnt lgkmcnt(1)
    v_mfma_f32_16x16x32_bf16 v[152:155], v[72:75], v[56:59], 0
    v_mfma_f32_16x16x32_bf16 v[156:159], v[80:83], v[56:59], 0
    s_waitcnt lgkmcnt(0)
    v_mfma_f32_16x16x32_bf16 v[152:155], v[76:79], v[60:63], v[152:155]
    v_mfma_f32_16x16x32_bf16 v[156:159], v[84:87], v[60:63], v[156:159]
    v_mfma_f32_16x16x32_bf16 v[160:163], v[88:91], v[56:59], 0
    v_mfma_f32_16x16x32_bf16 v[160:163], v[92:95], v[60:63], v[160:163]
    v_mfma_f32_16x16x32_bf16 v[164:167], v[96:99], v[56:59], 0
    v_mfma_f32_16x16x32_bf16 v[164:167], v[100:103], v[60:63], v[164:167]
    s_nop 2
    v_mov_b32 v16, v152
    v_bfi_b32 v17, s55, v2, v153
    v_mov_b32 v18, v154
    v_bfi_b32 v19, s55, v2, v155
    s_lshl_b64 exec, exec, 1
    v_mov_b32 v16, v156
    v_bfi_b32 v17, s55, v2, v157
    v_mov_b32 v18, v158
    v_bfi_b32 v19, s55, v2, v159
    s_lshl_b64 exec, exec, 1
    v_mov_b32 v16, v160
    v_bfi_b32 v17, s55, v2, v161
    v_mov_b32 v18, v162
    v_bfi_b32 v19, s55, v2, v163
    s_lshl_b64 exec, exec, 1
    v_mov_b32 v16, v164
    v_bfi_b32 v17, s55, v2, v165
    v_mov_b32 v18, v166
    v_bfi_b32 v19, s55, v2, v167
    s_mov_b32 exec_lo, 0xff00ff
    s_mov_b32 exec_hi, 0xff00ff
    buffer_store_dwordx4 v[16:19], v11, s[28:31], s72 offen sc1
    s_cmp_ge_u32 s2, 32
    s_cbranch_scc1 Ltailend110
    s_mov_b64 exec, -1
    v_lshrrev_b32 v10, 2, v0
    v_lshlrev_b32 v10, 7, v10
    v_and_b32 v4, 2, v0
    v_lshl_add_u32 v10, v4, 5, v10
    v_and_b32 v4, 1, v0
    v_lshl_add_u32 v10, v4, 4, v10
    s_lshl_b32 s50, s2, 13
    s_lshl_b32 s51, s68, 5
    s_add_u32 s50, s50, s51
    s_add_u32 s50, s50, 0xa0000
    s_add_u32 s51, s50, 4096
    v_lshlrev_b32 v66, 16, v66
    s_mov_b32 s32, s22
    s_mov_b32 s33, s23
    s_mov_b32 s34, 0x400
    s_mov_b32 s35, 0x20000
    s_waitcnt vmcnt(0)
    buffer_load_dwordx4 v[24:27], v10, s[28:31], s50 offen offset:0 sc1
    buffer_load_dwordx4 v[28:31], v10, s[28:31], s50 offen offset:2048 sc1
    buffer_load_dwordx4 v[32:35], v10, s[28:31], s51 offen offset:0 sc1
    buffer_load_dwordx4 v[36:39], v10, s[28:31], s51 offen offset:2048 sc1
    s_mov_b32 s58, 65536
Lpp111:
    buffer_load_dwordx4 v[40:43], v10, s[28:31], s50 offen offset:0 sc1
    buffer_load_dwordx4 v[44:47], v10, s[28:31], s50 offen offset:2048 sc1
    buffer_load_dwordx4 v[48:51], v10, s[28:31], s51 offen offset:0 sc1
    buffer_load_dwordx4 v[52:55], v10, s[28:31], s51 offen offset:2048 sc1
    s_waitcnt vmcnt(7)
    v_xor_b32 v25, v25, v2
    v_xor_b32 v27, v27, v2
    v_or_b32 v4, v25, v27
    s_waitcnt vmcnt(6)
    v_xor_b32 v29, v29, v2
    v_xor_b32 v31, v31, v2
    v_or3_b32 v4, v29, v31, v4
    v_pk_add_f32 v[20:21], v[24:25], v[28:29]
    v_pk_add_f32 v[22:23], v[26:27], v[30:31]
    s_waitcnt vmcnt(5)
    v_xor_b32 v33, v33, v2
    v_xor_b32 v35, v35, v2
    v_or3_b32 v4, v33, v35, v4
    v_pk_add_f32 v[20:21], v[20:21], v[32:33]
    v_pk_add_f32 v[22:23], v[22:23], v[34:35]
    s_waitcnt vmcnt(4)
    v_xor_b32 v37, v37, v2
    v_xor_b32 v39, v39, v2
    v_or3_b32 v4, v37, v39, v4
    v_pk_add_f32 v[20:21], v[20:21], v[36:37]
    v_pk_add_f32 v[22:23], v[22:23], v[38:39]
    v_and_b32 v4, s55, v4
    v_cmp_ne_u32 vcc, 0, v4
    s_cbranch_vccz Lppx112
    buffer_load_dwordx4 v[24:27], v10, s[28:31], s50 offen offset:0 sc1
    buffer_load_dwordx4 v[28:31], v10, s[28:31], s50 offen offset:2048 sc1
    buffer_load_dwordx4 v[32:35], v10, s[28:31], s51 offen offset:0 sc1
    buffer_load_dwordx4 v[36:39], v10, s[28:31], s51 offen offset:2048 sc1
    s_waitcnt vmcnt(7)
    v_xor_b32 v41, v41, v2
    v_xor_b32 v43, v43, v2
    v_or_b32 v4, v41, v43
    s_waitcnt vmcnt(6)
    v_xor_b32 v45, v45, v2
    v_xor_b32 v47, v47, v2
    v_or3_b32 v4, v45, v47, v4
    v_pk_add_f32 v[20:21], v[40:41], v[44:45]
    v_pk_add_f32 v[22:23], v[42:43], v[46:47]
    s_waitcnt vmcnt(5)
    v_xor_b32 v49, v49, v2
    v_xor_b32 v51, v51, v2
    v_or3_b32 v4, v49, v51, v4
    v_pk_add_f32 v[20:21], v[20:21], v[48:49]
    v_pk_add_f32 v[22:23], v[22:23], v[50:51]
    s_waitcnt vmcnt(4)
    v_xor_b32 v53, v53, v2
    v_xor_b32 v55, v55, v2
    v_or3_b32 v4, v53, v55, v4
    v_pk_add_f32 v[20:21], v[20:21], v[52:53]
    v_pk_add_f32 v[22:23], v[22:23], v[54:55]
    v_and_b32 v4, s55, v4
    v_cmp_ne_u32 vcc, 0, v4
    s_cbranch_vccz Lppx112
    s_sub_u32 s58, s58, 1
    s_cbranch_scc0 Lpp111
Lppx112:
    v_permlane32_swap_b32 v20, v22
    v_permlane32_swap_b32 v21, v23
    v_add_f32 v20, v20, v22
    v_add_f32 v21, v21, v23
    s_nop 1
    v_permlane16_swap_b32 v20, v21
    v_add_f32 v20, v20, v21
    s_nop 1
    v_add_f32_dpp v20, v20, v20 row_ror:4 row_mask:0xf bank_mask:0xf
    s_nop 1
    v_add_f32_dpp v20, v20, v20 row_ror:8 row_mask:0xf bank_mask:0xf
    v_cvt_pk_bf16_f32 v20, v20, v20
    v_and_b32 v20, s54, v20
    v_mul_f32 v4, 0xbfb8aa3b, v20
    v_exp_f32 v4, v4
    s_nop 0
    v_add_f32 v4, 1.0, v4
    v_rcp_f32 v4, v4
    s_nop 0
    v_mul_f32 v4, v20, v4
    v_cvt_pk_bf16_f32 v21, v4, v4
    v_and_b32 v21, s54, v21
    s_nop 1
    v_mul_f32_dpp v20, v21, v20 quad_perm:[2,3,2,3] row_mask:0xf bank_mask:0xf
    v_cvt_pk_bf16_f32 v20, v20, v20
    v_and_b32 v20, s54, v20
    v_add_f32 v20, v20, v66
    v_cvt_pk_bf16_f32 v20, v20, v20
    s_mov_b32 exec_lo, 0x30003
    s_mov_b32 exec_hi, 0x30003
    buffer_store_short v20, v67, s[32:35], 0 offen
    s_or_b32 s50, s2, s68
    s_cbranch_scc1 Ltailend110
    s_mov_b64 exec, 1
    v_mov_b32 v4, s59
    buffer_store_dword v4, v1, s[28:31], 0 offen offset:0
Ltailend110:
    s_endpgm
Lsw1:
    s_lshl_b32 s50, s48, 3
    s_lshr_b32 s51, s49, 2
    s_add_u32 s50, s50, s51
    s_lshl_b32 s50, s50, 10
    s_add_u32 s50, s50, 0x10000
    s_mov_b32 s58, 1048576
Llw113:
    ds_read_b32 v5, v1 offset:16
    s_waitcnt lgkmcnt(0)
    v_readfirstlane_b32 s53, v5
    s_nop 0
    s_cmp_ge_u32 s53, 44
    s_cbranch_scc1 Llwx114
    s_sub_u32 s58, s58, 1
    s_cbranch_scc1 Llwx114
    s_sleep 1
    s_branch Llw113
Llwx114:
    s_mov_b32 s58, 65536
Lpoll115:
    buffer_load_dwordx4 v[12:15], v3, s[28:31], s50 offen sc1
    s_waitcnt vmcnt(0)
    v_xor_b32 v13, v13, v2
    v_xor_b32 v15, v15, v2
    v_or_b32 v4, v13, v15
    v_and_b32 v4, s55, v4
    v_cmp_ne_u32 vcc, 0, v4
    s_cbranch_vccz Lpollx116
    s_sub_u32 s58, s58, 1
    s_cbranch_scc0 Lpoll115
Lpollx116:
    s_nop 0
    v_permlane32_swap_b32 v12, v14
    v_permlane32_swap_b32 v13, v15
    v_add_f32 v12, v12, v14
    v_add_f32 v13, v13, v15
    s_nop 1
    v_permlane16_swap_b32 v12, v13
    v_add_f32 v12, v12, v13
    v_cvt_pk_bf16_f32 v12, v12, v12
    v_and_b32 v12, s54, v12
    s_nop 1
    v_mov_b32_dpp v13, v12 row_ror:8 row_mask:0xf bank_mask:0xf
    v_mul_f32 v4, 0xbfb8aa3b, v12
    v_exp_f32 v4, v4
    s_nop 0
    v_add_f32 v4, 1.0, v4
    v_rcp_f32 v4, v4
    s_nop 0
    v_mul_f32 v4, v12, v4
    v_cvt_pk_bf16_f32 v12, v4, v4
    v_and_b32 v12, s54, v12
    v_mul_f32 v12, v12, v13
    v_cvt_pk_bf16_f32 v12, v12, v12
    v_and_b32 v4, 7, v0
    v_lshlrev_b32 v4, 3, v4
    v_lshrrev_b32 v5, 4, v0
    v_lshl_add_u32 v4, v5, 1, v4
    v_mov_b32 v5, 1
    s_mov_b32 exec_lo, 0xff00ff
    s_mov_b32 exec_hi, 0xff00ff
    ds_write_b16 v4, v12 offset:448
    s_mov_b64 exec, -1
    s_waitcnt lgkmcnt(0)
    ds_write_b32 v1, v5 offset:20
    s_endpgm
Lend:
    s_endpgm
Lcode_end:
    .fill 64, 4, 0xbf800000
    .section .rodata,"a"
    .p2align 6
    .amdhsa_kernel recurrent_scan__gqa_block_cached__swiglu_ffn__decode_kernel
    .amdhsa_next_free_vgpr 168
    .amdhsa_next_free_sgpr 102
    .amdhsa_accum_offset 168
    .amdhsa_group_segment_fixed_size 0
    .amdhsa_kernarg_size 96
    .amdhsa_user_sgpr_count 2
    .amdhsa_user_sgpr_kernarg_segment_ptr 1
    .amdhsa_system_sgpr_workgroup_id_x 1
    .amdhsa_float_denorm_mode_32 3
    .end_amdhsa_kernel
```
